```python
import torch

def _softmax(x, axis=-1):
    return torch.softmax(x, dim=axis)
def _gelu(x):
    return torch.nn.functional.gelu(x, approximate="tanh")
def _silu(x):
    return torch.nn.functional.silu(x)
def _sigmoid(x):
    return torch.sigmoid(x)
def _layernorm(x, axis=-1, eps=1e-5):
    m = x.mean(dim=axis, keepdim=True)
    v = x.var(dim=axis, keepdim=True, unbiased=False)
    return (x - m) / torch.sqrt(v + eps)
def _scatter_add(tgt, idx, src, axis=0):
    return tgt.clone().index_add_(axis, idx, src)
def _segment_sum(src, seg, n):
    out = torch.zeros((n,) + src.shape[1:], dtype=src.dtype)
    return out.index_add_(0, seg, src)
def _pad(x, pw):
    flat = tuple(v for pair in reversed(pw) for v in pair)
    return torch.nn.functional.pad(x, flat)

kernel_name = 'standalone__paged_block_table_kv_radixattention__decode'

def setup_inputs():

    _w = (lambda a: (lambda t: t.to(torch.bfloat16) if t.is_floating_point() else t)(torch.as_tensor(a)))
    B, H, Hkv, Dh = 4, 32, 8, 128
    Lk = 8192
    bs = 16
    nb = max(2, Lk // bs)
    P = max(1, nb // 2)
    n_phys = P + B * (nb - P)
    shared = torch.arange(P, dtype=torch.int64)
    priv = P + torch.arange(B * (nb - P), dtype=torch.int64).reshape(B, nb - P)
    bt = torch.cat([torch.tile(shared[None, :], (B, 1)), priv], dim=1)
    ctx = nb * bs - (torch.arange(1, B + 1, dtype=torch.int64) * 2654435761) % max(1, (nb * bs - P * bs) // 2)
    return {
        "q": _w((lambda *s: torch.randn(*s, dtype=torch.bfloat16) * 0.8)(B, H, Dh)),
        "k_cache": _w((lambda *s: torch.randn(*s, dtype=torch.bfloat16) * 0.8)(n_phys, bs, Hkv, Dh)),
        "v_cache": _w((lambda *s: torch.randn(*s, dtype=torch.bfloat16) * 0.05)(n_phys, bs, Hkv, Dh)),
        "block_table": _w(bt.to(torch.int64)),
        "ctx_lens": _w(torch.as_tensor(ctx).to(torch.int64)),
    }

def reference(q, k_cache, v_cache, block_table, ctx_lens):
    B, H, Dh = q.shape
    n_phys, bs, Hkv, _ = k_cache.shape
    nb = block_table.shape[1]
    Lk = nb * bs
    rep = H // Hkv
    k = k_cache[block_table].reshape(B, Lk, Hkv, Dh)
    v = v_cache[block_table].reshape(B, Lk, Hkv, Dh)
    k = (lambda x, n, axis: torch.repeat_interleave(x, n, dim=axis))(k, rep, axis=2)
    v = (lambda x, n, axis: torch.repeat_interleave(x, n, dim=axis))(v, rep, axis=2)
    scores = torch.einsum("bhd,bkhd->bhk", q, k) * (Dh ** -0.5)
    pos = torch.arange(Lk)
    valid = pos[None, :] < ctx_lens[:, None]
    scores = torch.where(valid[:, None, :], scores, -1e9)
    p = _softmax(scores, axis=-1)
    return torch.einsum("bhk,bkhd->bhd", p, v)
```

```asm
; @launch grid=(256,1,1) block=(512,1,1) lds=139264
.amdgcn_target "amdgcn-amd-amdhsa--gfx950"
.text
.globl standalone__paged_block_table_kv_radixattention__decode_kernel
.p2align 8
.type standalone__paged_block_table_kv_radixattention__decode_kernel,@function
standalone__paged_block_table_kv_radixattention__decode_kernel:
    s_load_dwordx2 s[20:21], s[0:1], 8
    s_load_dwordx16 s[4:19], s[0:1], 0
    v_lshlrev_b32 v2, 5, v0
    s_getpc_b64 s[96:97]
L_pc:
    global_load_dword v35, v2, s[96:97] offset:104
    s_cmpk_ge_u32 s2, 256
    s_cbranch_scc1 L_end
    v_readfirstlane_b32 s50, v0
    s_xor_b32 s48, s2, 3
    s_and_b32 s48, s48, 7
    s_lshr_b32 s49, s2, 3
    v_bfe_u32 v2, v0, 4, 2
    v_and_b32 v3, 15, v0
    v_lshlrev_b32 v1, 4, v0
    v_xor_b32 v14, v3, v2
    s_cmp_lg_u32 s50, 0
    v_lshlrev_b32 v14, 4, v14
    s_cbranch_scc1 L_nons
    s_lshl_b32 s95, s48, 8
    v_lshl_add_u32 v36, v2, 11, v14
    s_lshl_b32 s82, s49, 15
    v_add_u32 v36, s95, v36
    s_movk_i32 s92, 7168
    s_movk_i32 m0, 8192
    v_xor_b32 v38, 128, v36
    v_xor_b32 v37, 64, v36
    v_add_u32 v38, 14336, v38
    v_add_u32 v37, s92, v37
    v_xor_b32 v39, 64, v38
    s_mov_b32 s22, 41943040
    v_add_u32 v39, s92, v39
    s_mov_b32 s23, 0x20000
    s_waitcnt lgkmcnt(0)
L_burst:
    buffer_load_dwordx4 v36, s[20:23], s82 offen offset:0  lds
    buffer_load_dwordx4 v37, s[20:23], s82 offen offset:1024  lds
    buffer_load_dwordx4 v38, s[20:23], s82 offen offset:2048  lds
    buffer_load_dwordx4 v39, s[20:23], s82 offen offset:3072  lds
    s_addk_i32 m0, 4096
    s_add_u32 s82, s82, 1048576
    s_cmpk_lt_u32 m0, 32768
    s_cbranch_scc1 L_burst
    s_branch L_smain
L_nons:
    s_cmpk_lt_u32 s50, 256
    s_cbranch_scc1 L_notable
    s_waitcnt lgkmcnt(0)
    global_load_dwordx4 v[76:79], v1, s[10:11] offset:-4096
    global_load_dwordx4 v[80:83], v1, s[10:11]
    s_load_dwordx4 s[36:39], s[12:13], 0
    s_branch L_cmain
L_notable:
    v_mov_b32 v20, 0
    v_mov_b32 v21, 0
    v_mov_b32 v22, 0
    v_mov_b32 v23, 0
    ds_write_b128 v1, v[20:23]
    v_lshlrev_b32 v4, 1, v1
    v_add_u32 v4, 14440, v4
    v_min_u32 v4, (L_codeend - L_pc - 4), v4
    global_load_dword v5, v4, s[96:97]
    s_waitcnt lgkmcnt(0)
    s_barrier
    s_endpgm
L_smain:
    s_setprio 2
    s_lshl_b32 s92, s49, 15
    v_lshlrev_b32 v45, 16, v1
    v_add_u32 v45, s92, v45
    s_mov_b32 s86, s22
    s_mov_b64 s[84:85], -1
    s_mov_b32 s54, 0
    s_lshl_b32 s92, s48, 7
    s_add_u32 s92, s92, 2195456
    s_load_dword s57, s[18:19], s92
    v_mov_b32 v15, 0
    v_mov_b32 v17, v1
    s_mov_b32 s63, 4
    v_mov_b32 v43, 0
    v_lshrrev_b32 v44, 2, v1
    v_add_u32 v44, 2048, v44
    s_lshr_b32 s92, 42, s48
    s_bitcmp0_b32 s92, 0
    s_cselect_b64 s[90:91], -1, 0
    s_barrier
L_vround:
    s_mov_b64 vcc, s[90:91]
    s_bitcmp1_b32 s84, 6
    s_cselect_b32 s22, s86, 0
    s_mov_b32 m0, 32768
    v_readlane_b32 s83, v45, 7
    s_cbranch_vccz L_nw24
    s_waitcnt vmcnt(21)
L_nw24:
    buffer_load_dwordx4 v36, s[20:23], s82 offen offset:0  lds
    buffer_load_dwordx4 v37, s[20:23], s82 offen offset:1024  lds
    s_waitcnt vmcnt(24)
    s_cbranch_vccz L_nw26
    s_waitcnt vmcnt(21)
L_nw26:
    buffer_load_dwordx4 v38, s[20:23], s82 offen offset:2048  lds
    buffer_load_dwordx4 v39, s[20:23], s82 offen offset:3072  lds
    s_mov_b32 s24, s8
    s_mov_b32 s25, s9
    s_mov_b32 s27, 0x20000
    v_lshlrev_b32 v40, 13, v2
    v_lshl_add_u32 v40, v3, 4, v40
    v_add_u32 v40, s95, v40
    v_add_u32 v41, 4096, v40
    s_bitcmp1_b32 s84, 7
    s_cselect_b32 s22, s86, 0
    s_mov_b32 m0, 36864
    v_readlane_b32 s80, v45, 0
    s_waitcnt vmcnt(24)
    s_cbranch_vccz L_nw28
    s_waitcnt vmcnt(21)
L_nw28:
    buffer_load_dwordx4 v36, s[20:23], s83 offen offset:0  lds
    buffer_load_dwordx4 v37, s[20:23], s83 offen offset:1024  lds
    v_add_u32 v43, 1, v43
    ds_write_b32 v44, v43
    s_waitcnt vmcnt(24)
    s_cbranch_vccz L_nw30
    s_waitcnt vmcnt(21)
L_nw30:
    buffer_load_dwordx4 v38, s[20:23], s83 offen offset:2048  lds
    buffer_load_dwordx4 v39, s[20:23], s83 offen offset:3072  lds
    s_bitcmp1_b32 s84, 0
    s_cselect_b32 s26, s86, 0
    v_readlane_b32 s81, v45, 1
    s_waitcnt vmcnt(24)
    s_cbranch_vccz L_nw32
    s_waitcnt vmcnt(21)
L_nw32:
    buffer_load_dwordx4 v[80:83], v40, s[24:27], s80 offen offset:0
    buffer_load_dwordx4 v[84:87], v40, s[24:27], s80 offen offset:2048
    v_add_u32 v43, 1, v43
    ds_write_b32 v44, v43
    s_waitcnt vmcnt(24)
    s_cbranch_vccz L_nw34
    s_waitcnt vmcnt(21)
L_nw34:
    buffer_load_dwordx4 v[88:91], v41, s[24:27], s80 offen offset:0
    buffer_load_dwordx4 v[92:95], v41, s[24:27], s80 offen offset:2048
    s_bitcmp1_b32 s84, 1
    s_cselect_b32 s26, s86, 0
    v_readlane_b32 s82, v45, 2
    s_waitcnt vmcnt(24)
    s_cbranch_vccz L_nw36
    s_waitcnt vmcnt(21)
L_nw36:
    buffer_load_dwordx4 v[96:99], v40, s[24:27], s81 offen offset:0
    buffer_load_dwordx4 v[100:103], v40, s[24:27], s81 offen offset:2048
    v_add_u32 v43, 1, v43
    ds_write_b32 v44, v43
    s_waitcnt vmcnt(24)
    s_cbranch_vccz L_nw38
    s_waitcnt vmcnt(21)
L_nw38:
    buffer_load_dwordx4 v[104:107], v41, s[24:27], s81 offen offset:0
    buffer_load_dwordx4 v[108:111], v41, s[24:27], s81 offen offset:2048
    s_bitcmp1_b32 s84, 2
    s_cselect_b32 s26, s86, 0
    v_readlane_b32 s83, v45, 3
    s_waitcnt vmcnt(24)
    s_cbranch_vccz L_nw40
    s_waitcnt vmcnt(21)
L_nw40:
    buffer_load_dwordx4 v[112:115], v40, s[24:27], s82 offen offset:0
    buffer_load_dwordx4 v[116:119], v40, s[24:27], s82 offen offset:2048
    v_add_u32 v43, 1, v43
    ds_write_b32 v44, v43
    s_waitcnt vmcnt(24)
    s_cbranch_vccz L_nw42
    s_waitcnt vmcnt(21)
L_nw42:
    buffer_load_dwordx4 v[120:123], v41, s[24:27], s82 offen offset:0
    buffer_load_dwordx4 v[124:127], v41, s[24:27], s82 offen offset:2048
    s_bitcmp1_b32 s84, 3
    s_cselect_b32 s26, s86, 0
    v_readlane_b32 s80, v45, 4
    s_waitcnt vmcnt(24)
    s_cbranch_vccz L_nw44
    s_waitcnt vmcnt(21)
L_nw44:
    buffer_load_dwordx4 v[128:131], v40, s[24:27], s83 offen offset:0
    buffer_load_dwordx4 v[132:135], v40, s[24:27], s83 offen offset:2048
    v_add_u32 v43, 1, v43
    ds_write_b32 v44, v43
    s_waitcnt vmcnt(24)
    s_cbranch_vccz L_nw46
    s_waitcnt vmcnt(21)
L_nw46:
    buffer_load_dwordx4 v[136:139], v41, s[24:27], s83 offen offset:0
    buffer_load_dwordx4 v[140:143], v41, s[24:27], s83 offen offset:2048
    v_lshrrev_b32 v9, 4, v1
    v_and_b32 v10, 0x38, v9
    v_sub_u32 v10, s49, v10
    v_and_b32 v10, 31, v10
    v_lshl_add_u32 v10, v9, 5, v10
    v_lshlrev_b32 v10, 15, v10
    s_bitcmp1_b32 s84, 4
    s_cselect_b32 s26, s86, 0
    v_readlane_b32 s81, v45, 5
    s_waitcnt vmcnt(24)
    s_cbranch_vccz L_nw48
    s_waitcnt vmcnt(21)
L_nw48:
    buffer_load_dwordx4 v[144:147], v40, s[24:27], s80 offen offset:0
    buffer_load_dwordx4 v[148:151], v40, s[24:27], s80 offen offset:2048
    v_add_u32 v43, 1, v43
    ds_write_b32 v44, v43
    s_waitcnt vmcnt(24)
    s_cbranch_vccz L_nw50
    s_waitcnt vmcnt(21)
L_nw50:
    buffer_load_dwordx4 v[152:155], v41, s[24:27], s80 offen offset:0
    buffer_load_dwordx4 v[156:159], v41, s[24:27], s80 offen offset:2048
    s_bitcmp1_b32 s84, 5
    s_cselect_b32 s26, s86, 0
    s_waitcnt vmcnt(24)
    s_cbranch_vccz L_nw52
    s_waitcnt vmcnt(21)
L_nw52:
    buffer_load_dwordx4 v[160:163], v40, s[24:27], s81 offen offset:0
    ds_read_b32 v24, v15 offset:3088
    ds_read_b128 v[20:23], v17 offset:1024
    buffer_load_dwordx4 v[164:167], v40, s[24:27], s81 offen offset:2048
    v_add_u32 v43, 1, v43
    ds_write_b32 v44, v43
    s_waitcnt vmcnt(24)
    s_cbranch_vccz L_nw54
    s_waitcnt vmcnt(21)
L_nw54:
    buffer_load_dwordx4 v[168:171], v41, s[24:27], s81 offen offset:0
    s_cmp_lg_u32 s54, 0
    s_cbranch_scc1 L_vlist
    s_waitcnt lgkmcnt(0)
    v_cmp_gt_u32 vcc, 4, v24
    s_cbranch_vccz L_sl_ok
L_sl_again:
    ds_read_b32 v24, v15 offset:3088
    ds_read_b128 v[20:23], v17 offset:1024
    s_waitcnt lgkmcnt(0)
    v_cmp_gt_u32 vcc, 4, v24
    s_cbranch_vccnz L_sl_again
L_sl_ok:
    v_or3_b32 v20, v20, v21, v22
    v_or_b32 v20, v20, v23
    v_cmp_ne_u32 vcc, 0, v20
    s_nop 0
    s_lshr_b64 s[72:73], vcc, 8
    s_bcnt1_i32_b32 s55, s72
    s_and_b32 s92, vcc_lo, 0xff
    s_and_b32 vcc_hi, vcc_hi, 0xff
    s_or_b32 vcc_lo, vcc_lo, 0xff
    v_mbcnt_lo_u32_b32 v8, vcc_lo, 0
    v_mbcnt_hi_u32_b32 v8, vcc_hi, v8
    s_bfm_b64 s[84:85], s55, 8
    v_cndmask_b32 v8, 63, v8, vcc
    s_or_b32 s56, s84, s92
    v_lshlrev_b32 v8, 2, v8
    s_or_b32 s84, s84, 0xff
    ds_permute_b32 v45, v8, v10
    s_add_u32 s57, s57, 1
    s_lshr_b32 s92, s57, 8
    s_addk_i32 s92, 0x5a
    v_mad_u32_u24 v18, v3, 37, s57
    v_mad_u32_u24 v8, v3, 59, s92
    s_mov_b32 s92, 0x0c0c0400
    v_perm_b32 v18, v8, v18, s92
    s_waitcnt lgkmcnt(0)
    s_mov_b64 vcc, s[90:91]
L_vlist:
    v_readlane_b32 s82, v45, 8
    buffer_load_dwordx4 v[172:175], v41, s[24:27], s81 offen offset:2048
    s_bitcmp1_b32 s84, 8
    s_cselect_b32 s22, s86, 0
    s_mov_b32 m0, 40960
    v_readlane_b32 s83, v45, 9
    s_waitcnt vmcnt(24)
    s_cbranch_vccz L_nw56
    s_waitcnt vmcnt(21)
L_nw56:
    buffer_load_dwordx4 v36, s[20:23], s82 offen offset:0  lds
    s_mov_b32 s84, s56
    buffer_load_dwordx4 v37, s[20:23], s82 offen offset:1024  lds
    v_add_u32 v43, 1, v43
    ds_write_b32 v44, v43
    s_waitcnt vmcnt(24)
    s_cbranch_vccz L_nw58
    s_waitcnt vmcnt(21)
L_nw58:
    buffer_load_dwordx4 v38, s[20:23], s82 offen offset:2048  lds
    buffer_load_dwordx4 v39, s[20:23], s82 offen offset:3072  lds
    s_bitcmp1_b32 s84, 9
    s_cselect_b32 s22, s86, 0
    s_mov_b32 m0, 45056
    v_readlane_b32 s80, v45, 10
    s_waitcnt vmcnt(24)
    s_cbranch_vccz L_nw60
    s_waitcnt vmcnt(21)
L_nw60:
    buffer_load_dwordx4 v36, s[20:23], s83 offen offset:0  lds
    buffer_load_dwordx4 v37, s[20:23], s83 offen offset:1024  lds
    s_waitcnt vmcnt(24)
    s_cbranch_vccz L_nw62
    s_waitcnt vmcnt(21)
L_nw62:
    buffer_load_dwordx4 v38, s[20:23], s83 offen offset:2048  lds
    buffer_load_dwordx4 v39, s[20:23], s83 offen offset:3072  lds
    s_bitcmp1_b32 s84, 10
    s_cselect_b32 s22, s86, 0
    s_mov_b32 m0, 49152
    v_readlane_b32 s81, v45, 11
    s_waitcnt vmcnt(24)
    s_cbranch_vccz L_nw64
    s_waitcnt vmcnt(21)
L_nw64:
    buffer_load_dwordx4 v36, s[20:23], s80 offen offset:0  lds
    buffer_load_dwordx4 v37, s[20:23], s80 offen offset:1024  lds
    s_mov_b32 s32, s18
    s_mov_b32 s33, s19
    s_mov_b32 s34, 268435456
    s_mov_b32 s35, 0x20000
    s_mov_b32 s61, 0x05040100
    s_mov_b32 s62, 0x07060302
    s_mov_b32 s39, 0x07060500
    s_mov_b32 s40, 0x07060501
    s_waitcnt vmcnt(24)
    s_cbranch_vccz L_nw66
    s_waitcnt vmcnt(21)
L_nw66:
    buffer_load_dwordx4 v38, s[20:23], s80 offen offset:2048  lds
    buffer_load_dwordx4 v39, s[20:23], s80 offen offset:3072  lds
    s_bitcmp1_b32 s84, 11
    s_cselect_b32 s22, s86, 0
    s_mov_b32 m0, 53248
    v_readlane_b32 s82, v45, 12
    s_waitcnt vmcnt(24)
    s_cbranch_vccz L_nw68
    s_waitcnt vmcnt(21)
L_nw68:
    buffer_load_dwordx4 v36, s[20:23], s81 offen offset:0  lds
    buffer_load_dwordx4 v37, s[20:23], s81 offen offset:1024  lds
    s_lshl_b32 s92, s48, 18
    s_lshl_b32 s93, s49, 8
    s_add_u32 s92, s92, s93
    v_lshlrev_b32 v42, 16, v2
    v_lshl_add_u32 v42, v3, 4, v42
    v_add_u32 v42, s92, v42
    s_waitcnt vmcnt(24)
    s_cbranch_vccz L_nw70
    s_waitcnt vmcnt(21)
L_nw70:
    buffer_load_dwordx4 v38, s[20:23], s81 offen offset:2048  lds
    buffer_load_dwordx4 v39, s[20:23], s81 offen offset:3072  lds
    s_bitcmp1_b32 s84, 12
    s_cselect_b32 s22, s86, 0
    s_mov_b32 m0, 57344
    v_readlane_b32 s83, v45, 13
    s_waitcnt vmcnt(24)
    s_cbranch_vccz L_nw72
    s_waitcnt vmcnt(21)
L_nw72:
    buffer_load_dwordx4 v36, s[20:23], s82 offen offset:0  lds
    buffer_load_dwordx4 v37, s[20:23], s82 offen offset:1024  lds
    s_mov_b32 s65, 8192
    s_mov_b32 s66, 16384
    s_mov_b32 s67, 24576
    s_mov_b32 s68, 32768
    s_mov_b32 s69, 40960
    s_mov_b32 s70, 49152
    s_mov_b32 s71, 57344
    s_waitcnt vmcnt(24)
    s_cbranch_vccz L_nw74
    s_waitcnt vmcnt(21)
L_nw74:
    buffer_load_dwordx4 v38, s[20:23], s82 offen offset:2048  lds
    buffer_load_dwordx4 v39, s[20:23], s82 offen offset:3072  lds
    s_bitcmp1_b32 s84, 13
    s_cselect_b32 s22, s86, 0
    s_mov_b32 m0, 61440
    v_readlane_b32 s80, v45, 14
    s_waitcnt vmcnt(24)
    s_cbranch_vccz L_nw76
    s_waitcnt vmcnt(21)
L_nw76:
    buffer_load_dwordx4 v36, s[20:23], s83 offen offset:0  lds
    buffer_load_dwordx4 v37, s[20:23], s83 offen offset:1024  lds
    s_cmp_lg_u32 s54, 0
    s_cbranch_scc1 L_nz0
    v_mov_b32 v48, 0
    v_mov_b32 v49, 0
    v_mov_b32 v50, 0
    v_mov_b32 v51, 0
    v_mov_b32 v52, 0
    v_mov_b32 v53, 0
    v_mov_b32 v54, 0
    v_mov_b32 v55, 0
L_nz0:
    s_waitcnt vmcnt(24)
    s_cbranch_vccz L_nw78
    s_waitcnt vmcnt(21)
L_nw78:
    buffer_load_dwordx4 v38, s[20:23], s83 offen offset:2048  lds
    buffer_load_dwordx4 v39, s[20:23], s83 offen offset:3072  lds
    s_bitcmp1_b32 s84, 14
    s_cselect_b32 s22, s86, 0
    s_mov_b32 m0, 65536
    v_readlane_b32 s81, v45, 15
    s_waitcnt vmcnt(24)
    s_cbranch_vccz L_nw80
    s_waitcnt vmcnt(21)
L_nw80:
    buffer_load_dwordx4 v36, s[20:23], s80 offen offset:0  lds
    buffer_load_dwordx4 v37, s[20:23], s80 offen offset:1024  lds
    s_cmp_lg_u32 s54, 0
    s_cbranch_scc1 L_nz1
    v_mov_b32 v56, 0
    v_mov_b32 v57, 0
    v_mov_b32 v58, 0
    v_mov_b32 v59, 0
    v_mov_b32 v60, 0
    v_mov_b32 v61, 0
    v_mov_b32 v62, 0
    v_mov_b32 v63, 0
L_nz1:
    s_waitcnt vmcnt(24)
    s_cbranch_vccz L_nw82
    s_waitcnt vmcnt(21)
L_nw82:
    buffer_load_dwordx4 v38, s[20:23], s80 offen offset:2048  lds
    buffer_load_dwordx4 v39, s[20:23], s80 offen offset:3072  lds
    s_bitcmp1_b32 s84, 15
    s_cselect_b32 s22, s86, 0
    s_mov_b32 m0, 69632
    v_readlane_b32 s82, v45, 16
    s_waitcnt vmcnt(24)
    s_cbranch_vccz L_nw84
    s_waitcnt vmcnt(21)
L_nw84:
    buffer_load_dwordx4 v36, s[20:23], s81 offen offset:0  lds
    buffer_load_dwordx4 v37, s[20:23], s81 offen offset:1024  lds
    s_cmp_lg_u32 s54, 0
    s_cbranch_scc1 L_nz2
    v_mov_b32 v64, 0
    v_mov_b32 v65, 0
    v_mov_b32 v66, 0
    v_mov_b32 v67, 0
    v_mov_b32 v68, 0
    v_mov_b32 v69, 0
    v_mov_b32 v70, 0
    v_mov_b32 v71, 0
L_nz2:
    v_add_u32 v43, 1, v43
    ds_write_b32 v44, v43
    s_waitcnt vmcnt(24)
    s_cbranch_vccz L_nw86
    s_waitcnt vmcnt(21)
L_nw86:
    buffer_load_dwordx4 v38, s[20:23], s81 offen offset:2048  lds
    buffer_load_dwordx4 v39, s[20:23], s81 offen offset:3072  lds
    s_bitcmp1_b32 s84, 16
    s_cselect_b32 s22, s86, 0
    s_mov_b32 m0, 73728
    v_readlane_b32 s83, v45, 17
    s_waitcnt vmcnt(24)
    s_cbranch_vccz L_nw88
    s_waitcnt vmcnt(21)
L_nw88:
    buffer_load_dwordx4 v36, s[20:23], s82 offen offset:0  lds
    buffer_load_dwordx4 v37, s[20:23], s82 offen offset:1024  lds
    s_cmp_lg_u32 s54, 0
    s_cbranch_scc1 L_nz3
    v_mov_b32 v72, 0
    v_mov_b32 v73, 0
    v_mov_b32 v74, 0
    v_mov_b32 v75, 0
    v_mov_b32 v76, 0
    v_mov_b32 v77, 0
    v_mov_b32 v78, 0
    v_mov_b32 v79, 0
L_nz3:
    v_add_u32 v43, 1, v43
    ds_write_b32 v44, v43
    s_waitcnt vmcnt(24)
    s_cbranch_vccz L_nw90
    s_waitcnt vmcnt(21)
L_nw90:
    buffer_load_dwordx4 v38, s[20:23], s82 offen offset:2048  lds
    buffer_load_dwordx4 v39, s[20:23], s82 offen offset:3072  lds
    s_bitcmp1_b32 s84, 17
    s_cselect_b32 s22, s86, 0
    s_mov_b32 m0, 77824
    v_readlane_b32 s80, v45, 18
    s_waitcnt vmcnt(24)
    s_cbranch_vccz L_nw92
    s_waitcnt vmcnt(21)
L_nw92:
    buffer_load_dwordx4 v36, s[20:23], s83 offen offset:0  lds
    buffer_load_dwordx4 v37, s[20:23], s83 offen offset:1024  lds
    v_add_u32 v43, 1, v43
    ds_write_b32 v44, v43
    s_waitcnt vmcnt(24)
    s_cbranch_vccz L_nw94
    s_waitcnt vmcnt(21)
L_nw94:
    buffer_load_dwordx4 v38, s[20:23], s83 offen offset:2048  lds
    buffer_load_dwordx4 v39, s[20:23], s83 offen offset:3072  lds
    s_bitcmp1_b32 s84, 18
    s_cselect_b32 s22, s86, 0
    s_mov_b32 m0, 81920
    v_readlane_b32 s81, v45, 19
    s_waitcnt vmcnt(24)
    s_cbranch_vccz L_nw96
    s_waitcnt vmcnt(21)
L_nw96:
    buffer_load_dwordx4 v36, s[20:23], s80 offen offset:0  lds
    buffer_load_dwordx4 v37, s[20:23], s80 offen offset:1024  lds
    v_add_u32 v43, 1, v43
    ds_write_b32 v44, v43
    s_waitcnt vmcnt(24)
    s_cbranch_vccz L_nw98
    s_waitcnt vmcnt(21)
L_nw98:
    buffer_load_dwordx4 v38, s[20:23], s80 offen offset:2048  lds
    buffer_load_dwordx4 v39, s[20:23], s80 offen offset:3072  lds
    s_bitcmp1_b32 s84, 19
    s_cselect_b32 s22, s86, 0
    s_mov_b32 m0, 86016
    v_readlane_b32 s82, v45, 20
    s_waitcnt vmcnt(24)
    s_cbranch_vccz L_nw100
    s_waitcnt vmcnt(21)
L_nw100:
    buffer_load_dwordx4 v36, s[20:23], s81 offen offset:0  lds
    buffer_load_dwordx4 v37, s[20:23], s81 offen offset:1024  lds
    v_add_u32 v43, 1, v43
    ds_write_b32 v44, v43
    s_waitcnt vmcnt(24)
    s_cbranch_vccz L_nw102
    s_waitcnt vmcnt(21)
L_nw102:
    buffer_load_dwordx4 v38, s[20:23], s81 offen offset:2048  lds
    buffer_load_dwordx4 v39, s[20:23], s81 offen offset:3072  lds
    s_bitcmp1_b32 s84, 20
    s_cselect_b32 s22, s86, 0
    s_mov_b32 m0, 90112
    v_readlane_b32 s83, v45, 21
    s_waitcnt vmcnt(24)
    s_cbranch_vccz L_nw104
    s_waitcnt vmcnt(21)
L_nw104:
    buffer_load_dwordx4 v36, s[20:23], s82 offen offset:0  lds
    buffer_load_dwordx4 v37, s[20:23], s82 offen offset:1024  lds
    v_add_u32 v43, 1, v43
    ds_write_b32 v44, v43
    s_waitcnt vmcnt(24)
    s_cbranch_vccz L_nw106
    s_waitcnt vmcnt(21)
L_nw106:
    buffer_load_dwordx4 v38, s[20:23], s82 offen offset:2048  lds
    buffer_load_dwordx4 v39, s[20:23], s82 offen offset:3072  lds
    s_bitcmp1_b32 s84, 21
    s_cselect_b32 s22, s86, 0
    s_mov_b32 m0, 94208
    v_readlane_b32 s80, v45, 22
    s_waitcnt vmcnt(24)
    s_cbranch_vccz L_nw108
    s_waitcnt vmcnt(21)
L_nw108:
    buffer_load_dwordx4 v36, s[20:23], s83 offen offset:0  lds
    buffer_load_dwordx4 v37, s[20:23], s83 offen offset:1024  lds
    v_add_u32 v43, 1, v43
    ds_write_b32 v44, v43
    s_waitcnt vmcnt(24)
    s_cbranch_vccz L_nw110
    s_waitcnt vmcnt(21)
L_nw110:
    buffer_load_dwordx4 v38, s[20:23], s83 offen offset:2048  lds
    buffer_load_dwordx4 v39, s[20:23], s83 offen offset:3072  lds
    s_bitcmp1_b32 s84, 22
    s_cselect_b32 s22, s86, 0
    s_mov_b32 m0, 98304
    v_readlane_b32 s81, v45, 23
    s_waitcnt vmcnt(24)
    s_cbranch_vccz L_nw112
    s_waitcnt vmcnt(21)
L_nw112:
    buffer_load_dwordx4 v36, s[20:23], s80 offen offset:0  lds
    buffer_load_dwordx4 v37, s[20:23], s80 offen offset:1024  lds
    v_add_u32 v43, 1, v43
    ds_write_b32 v44, v43
    s_waitcnt vmcnt(24)
    s_cbranch_vccz L_nw114
    s_waitcnt vmcnt(21)
L_nw114:
    buffer_load_dwordx4 v38, s[20:23], s80 offen offset:2048  lds
    buffer_load_dwordx4 v39, s[20:23], s80 offen offset:3072  lds
    s_bitcmp1_b32 s84, 23
    s_cselect_b32 s22, s86, 0
    s_mov_b32 m0, 102400
    v_readlane_b32 s82, v45, 24
    s_waitcnt vmcnt(24)
    s_cbranch_vccz L_nw116
    s_waitcnt vmcnt(21)
L_nw116:
    buffer_load_dwordx4 v36, s[20:23], s81 offen offset:0  lds
    buffer_load_dwordx4 v37, s[20:23], s81 offen offset:1024  lds
    v_add_u32 v43, 1, v43
    ds_write_b32 v44, v43
    s_waitcnt vmcnt(24)
    s_cbranch_vccz L_nw118
    s_waitcnt vmcnt(21)
L_nw118:
    buffer_load_dwordx4 v38, s[20:23], s81 offen offset:2048  lds
    buffer_load_dwordx4 v39, s[20:23], s81 offen offset:3072  lds
    s_bitcmp1_b32 s84, 24
    s_cselect_b32 s22, s86, 0
    s_mov_b32 m0, 106496
    v_readlane_b32 s83, v45, 25
    s_waitcnt vmcnt(24)
    s_cbranch_vccz L_nw120
    s_waitcnt vmcnt(21)
L_nw120:
    buffer_load_dwordx4 v36, s[20:23], s82 offen offset:0  lds
    buffer_load_dwordx4 v37, s[20:23], s82 offen offset:1024  lds
    v_add_u32 v43, 1, v43
    ds_write_b32 v44, v43
    s_waitcnt vmcnt(24)
    s_cbranch_vccz L_nw122
    s_waitcnt vmcnt(21)
L_nw122:
    buffer_load_dwordx4 v38, s[20:23], s82 offen offset:2048  lds
    buffer_load_dwordx4 v39, s[20:23], s82 offen offset:3072  lds
    s_bitcmp1_b32 s84, 25
    s_cselect_b32 s22, s86, 0
    s_mov_b32 m0, 110592
    v_readlane_b32 s80, v45, 26
    s_waitcnt vmcnt(24)
    s_cbranch_vccz L_nw124
    s_waitcnt vmcnt(21)
L_nw124:
    buffer_load_dwordx4 v36, s[20:23], s83 offen offset:0  lds
    buffer_load_dwordx4 v37, s[20:23], s83 offen offset:1024  lds
    v_add_u32 v43, 1, v43
    ds_write_b32 v44, v43
    s_waitcnt vmcnt(24)
    s_cbranch_vccz L_nw126
    s_waitcnt vmcnt(21)
L_nw126:
    buffer_load_dwordx4 v38, s[20:23], s83 offen offset:2048  lds
    buffer_load_dwordx4 v39, s[20:23], s83 offen offset:3072  lds
    s_bitcmp1_b32 s84, 26
    s_cselect_b32 s22, s86, 0
    s_mov_b32 m0, 114688
    v_readlane_b32 s81, v45, 27
    s_waitcnt vmcnt(24)
    s_cbranch_vccz L_nw128
    s_waitcnt vmcnt(21)
L_nw128:
    buffer_load_dwordx4 v36, s[20:23], s80 offen offset:0  lds
    buffer_load_dwordx4 v37, s[20:23], s80 offen offset:1024  lds
    v_add_u32 v43, 1, v43
    ds_write_b32 v44, v43
    s_waitcnt vmcnt(24)
    s_cbranch_vccz L_nw130
    s_waitcnt vmcnt(21)
L_nw130:
    buffer_load_dwordx4 v38, s[20:23], s80 offen offset:2048  lds
    buffer_load_dwordx4 v39, s[20:23], s80 offen offset:3072  lds
    s_bitcmp1_b32 s84, 27
    s_cselect_b32 s22, s86, 0
    s_mov_b32 m0, 118784
    v_readlane_b32 s82, v45, 28
    s_waitcnt vmcnt(24)
    s_cbranch_vccz L_nw132
    s_waitcnt vmcnt(21)
L_nw132:
    buffer_load_dwordx4 v36, s[20:23], s81 offen offset:0  lds
    buffer_load_dwordx4 v37, s[20:23], s81 offen offset:1024  lds
    v_add_u32 v43, 1, v43
    ds_write_b32 v44, v43
    s_waitcnt vmcnt(24)
    s_cbranch_vccz L_nw134
    s_waitcnt vmcnt(21)
L_nw134:
    buffer_load_dwordx4 v38, s[20:23], s81 offen offset:2048  lds
    buffer_load_dwordx4 v39, s[20:23], s81 offen offset:3072  lds
    s_bitcmp1_b32 s84, 28
    s_cselect_b32 s22, s86, 0
    s_mov_b32 m0, 122880
    v_readlane_b32 s83, v45, 29
    s_waitcnt vmcnt(21)
    buffer_load_dwordx4 v36, s[20:23], s82 offen offset:0  lds
    buffer_load_dwordx4 v37, s[20:23], s82 offen offset:1024  lds
    v_add_u32 v43, 1, v43
    ds_write_b32 v44, v43
    s_waitcnt vmcnt(21)
    buffer_load_dwordx4 v38, s[20:23], s82 offen offset:2048  lds
    buffer_load_dwordx4 v39, s[20:23], s82 offen offset:3072  lds
    v_add_u32 v43, 1, v43
    ds_write_b32 v44, v43
    s_bitcmp1_b32 s84, 29
    s_cselect_b32 s22, s86, 0
    s_mov_b32 m0, 126976
    v_readlane_b32 s80, v45, 30
    s_waitcnt vmcnt(21)
    buffer_load_dwordx4 v36, s[20:23], s83 offen offset:0  lds
    buffer_load_dwordx4 v37, s[20:23], s83 offen offset:1024  lds
    ds_read_b32 v6, v15 offset:3076
    ds_read_b128 v[20:23], v17 offset:8192
    ds_read_b32 v4, v44 offset:256
    s_waitcnt vmcnt(21)
    buffer_load_dwordx4 v38, s[20:23], s83 offen offset:2048  lds
    buffer_load_dwordx4 v39, s[20:23], s83 offen offset:3072  lds
    s_waitcnt lgkmcnt(0)
    v_cmp_gt_u32 vcc, s63, v6
    s_cbranch_vccnz L_pagain0
L_pok0:
    s_add_u32 s63, s63, 4
    v_pk_mul_f32 v[48:49], v[48:49], v[4:5] op_sel_hi:[1,0]
    v_pk_mul_f32 v[50:51], v[50:51], v[4:5] op_sel_hi:[1,0]
    v_pk_mul_f32 v[52:53], v[52:53], v[4:5] op_sel_hi:[1,0]
    v_pk_mul_f32 v[54:55], v[54:55], v[4:5] op_sel_hi:[1,0]
    v_pk_mul_f32 v[56:57], v[56:57], v[4:5] op_sel_hi:[1,0]
    v_pk_mul_f32 v[58:59], v[58:59], v[4:5] op_sel_hi:[1,0]
    v_pk_mul_f32 v[60:61], v[60:61], v[4:5] op_sel_hi:[1,0]
    v_pk_mul_f32 v[62:63], v[62:63], v[4:5] op_sel_hi:[1,0]
    v_pk_mul_f32 v[64:65], v[64:65], v[4:5] op_sel_hi:[1,0]
    v_pk_mul_f32 v[66:67], v[66:67], v[4:5] op_sel_hi:[1,0]
    v_pk_mul_f32 v[68:69], v[68:69], v[4:5] op_sel_hi:[1,0]
    v_pk_mul_f32 v[70:71], v[70:71], v[4:5] op_sel_hi:[1,0]
    v_pk_mul_f32 v[72:73], v[72:73], v[4:5] op_sel_hi:[1,0]
    v_pk_mul_f32 v[74:75], v[74:75], v[4:5] op_sel_hi:[1,0]
    v_pk_mul_f32 v[76:77], v[76:77], v[4:5] op_sel_hi:[1,0]
    v_pk_mul_f32 v[78:79], v[78:79], v[4:5] op_sel_hi:[1,0]
    s_mov_b64 vcc, s[90:91]
    s_bitcmp1_b32 s84, 30
    s_cselect_b32 s22, s86, 0
    s_mov_b32 m0, 131072
    v_readlane_b32 s81, v45, 31
    s_waitcnt vmcnt(21)
    buffer_load_dwordx4 v36, s[20:23], s80 offen offset:0  lds
    buffer_load_dwordx4 v37, s[20:23], s80 offen offset:1024  lds
    v_add_u32 v43, 1, v43
    ds_write_b32 v44, v43
    s_bitcmp0_b32 s84, 0
    s_cbranch_scc1 L_vbad0
L_vgood0:
    v_perm_b32 v208, v84, v80, s61
    v_perm_b32 v212, v84, v80, s62
    v_perm_b32 v216, v85, v81, s61
    v_perm_b32 v220, v85, v81, s62
    v_perm_b32 v224, v86, v82, s61
    v_perm_b32 v228, v86, v82, s62
    v_perm_b32 v232, v87, v83, s61
    v_perm_b32 v236, v87, v83, s62
    s_waitcnt vmcnt(21)
    buffer_load_dwordx4 v38, s[20:23], s80 offen offset:2048  lds
    buffer_load_dwordx4 v39, s[20:23], s80 offen offset:3072  lds
    v_add_u32 v43, 1, v43
    ds_write_b32 v44, v43
    s_bitcmp0_b32 s84, 0
    s_cbranch_scc1 L_vbad1
L_vgood1:
    ds_read_b128 v[24:27], v17 offset:9216
    v_perm_b32 v209, v92, v88, s61
    v_perm_b32 v213, v92, v88, s62
    v_perm_b32 v217, v93, v89, s61
    v_perm_b32 v221, v93, v89, s62
    v_perm_b32 v225, v94, v90, s61
    v_perm_b32 v229, v94, v90, s62
    v_perm_b32 v233, v95, v91, s61
    v_perm_b32 v237, v95, v91, s62
    s_bitcmp1_b32 s84, 31
    s_cselect_b32 s22, s86, 0
    s_mov_b32 m0, 135168
    v_readlane_b32 s82, v45, 6
    s_waitcnt vmcnt(21)
    buffer_load_dwordx4 v36, s[20:23], s81 offen offset:0  lds
    buffer_load_dwordx4 v37, s[20:23], s81 offen offset:1024  lds
    s_bitcmp0_b32 s84, 1
    s_cbranch_scc1 L_vbad2
L_vgood2:
    v_perm_b32 v210, v100, v96, s61
    v_perm_b32 v214, v100, v96, s62
    v_perm_b32 v218, v101, v97, s61
    v_perm_b32 v222, v101, v97, s62
    v_perm_b32 v226, v102, v98, s61
    v_perm_b32 v230, v102, v98, s62
    v_perm_b32 v234, v103, v99, s61
    v_perm_b32 v238, v103, v99, s62
    s_waitcnt vmcnt(21)
    buffer_load_dwordx4 v38, s[20:23], s81 offen offset:2048  lds
    buffer_load_dwordx4 v39, s[20:23], s81 offen offset:3072  lds
    v_add_u32 v43, 1, v43
    ds_write_b32 v44, v43
    s_bitcmp0_b32 s84, 1
    s_cbranch_scc1 L_vbad3
L_vgood3:
    v_perm_b32 v211, v108, v104, s61
    v_perm_b32 v215, v108, v104, s62
    v_perm_b32 v219, v109, v105, s61
    v_perm_b32 v223, v109, v105, s62
    v_perm_b32 v227, v110, v106, s61
    v_perm_b32 v231, v110, v106, s62
    v_perm_b32 v235, v111, v107, s61
    v_perm_b32 v239, v111, v107, s62
    s_bitcmp1_b32 s84, 6
    s_cselect_b32 s26, s86, 0
    v_readlane_b32 s83, v45, 7
    s_waitcnt vmcnt(21)
    buffer_load_dwordx4 v[176:179], v40, s[24:27], s82 offen offset:0
    buffer_load_dwordx4 v[180:183], v40, s[24:27], s82 offen offset:2048
    s_bitcmp0_b32 s84, 2
    s_cbranch_scc1 L_vbad4
L_vgood4:
    v_mfma_f32_16x16x32_bf16 v[48:51], v[208:211], v[20:23], v[48:51]
    v_perm_b32 v208, v116, v112, s61
    v_mfma_f32_16x16x32_bf16 v[52:55], v[212:215], v[20:23], v[52:55]
    v_perm_b32 v212, v116, v112, s62
    v_mfma_f32_16x16x32_bf16 v[56:59], v[216:219], v[20:23], v[56:59]
    v_perm_b32 v216, v117, v113, s61
    v_mfma_f32_16x16x32_bf16 v[60:63], v[220:223], v[20:23], v[60:63]
    v_perm_b32 v220, v117, v113, s62
    v_mfma_f32_16x16x32_bf16 v[64:67], v[224:227], v[20:23], v[64:67]
    v_perm_b32 v224, v118, v114, s61
    v_mfma_f32_16x16x32_bf16 v[68:71], v[228:231], v[20:23], v[68:71]
    v_perm_b32 v228, v118, v114, s62
    v_mfma_f32_16x16x32_bf16 v[72:75], v[232:235], v[20:23], v[72:75]
    v_perm_b32 v232, v119, v115, s61
    v_mfma_f32_16x16x32_bf16 v[76:79], v[236:239], v[20:23], v[76:79]
    v_perm_b32 v236, v119, v115, s62
    s_waitcnt vmcnt(21)
    buffer_load_dwordx4 v[184:187], v41, s[24:27], s82 offen offset:0
    buffer_load_dwordx4 v[188:191], v41, s[24:27], s82 offen offset:2048
    v_add_u32 v43, 1, v43
    ds_write_b32 v44, v43
    s_bitcmp0_b32 s84, 2
    s_cbranch_scc1 L_vbad5
L_vgood5:
    ds_read_b128 v[20:23], v17 offset:10240
    v_perm_b32 v209, v124, v120, s61
    v_perm_b32 v213, v124, v120, s62
    v_perm_b32 v217, v125, v121, s61
    v_perm_b32 v221, v125, v121, s62
    v_perm_b32 v225, v126, v122, s61
    v_perm_b32 v229, v126, v122, s62
    v_perm_b32 v233, v127, v123, s61
    v_perm_b32 v237, v127, v123, s62
    s_bitcmp1_b32 s84, 7
    s_cselect_b32 s26, s86, 0
    v_readlane_b32 s80, v45, 8
    s_waitcnt vmcnt(21)
    buffer_load_dwordx4 v[192:195], v40, s[24:27], s83 offen offset:0
    buffer_load_dwordx4 v[196:199], v40, s[24:27], s83 offen offset:2048
    s_bitcmp0_b32 s84, 3
    s_cbranch_scc1 L_vbad6
L_vgood6:
    v_perm_b32 v210, v132, v128, s61
    v_perm_b32 v214, v132, v128, s62
    v_perm_b32 v218, v133, v129, s61
    v_perm_b32 v222, v133, v129, s62
    v_perm_b32 v226, v134, v130, s61
    v_perm_b32 v230, v134, v130, s62
    v_perm_b32 v234, v135, v131, s61
    v_perm_b32 v238, v135, v131, s62
    s_waitcnt vmcnt(21)
    buffer_load_dwordx4 v[200:203], v41, s[24:27], s83 offen offset:0
    buffer_load_dwordx4 v[204:207], v41, s[24:27], s83 offen offset:2048
    v_add_u32 v43, 1, v43
    ds_write_b32 v44, v43
    s_bitcmp0_b32 s84, 3
    s_cbranch_scc1 L_vbad7
L_vgood7:
    v_perm_b32 v211, v140, v136, s61
    v_perm_b32 v215, v140, v136, s62
    v_perm_b32 v219, v141, v137, s61
    v_perm_b32 v223, v141, v137, s62
    v_perm_b32 v227, v142, v138, s61
    v_perm_b32 v231, v142, v138, s62
    v_perm_b32 v235, v143, v139, s61
    v_perm_b32 v239, v143, v139, s62
    s_bitcmp1_b32 s84, 8
    s_cselect_b32 s26, s86, 0
    v_readlane_b32 s81, v45, 9
    s_waitcnt vmcnt(21)
    buffer_load_dwordx4 v[80:83], v40, s[24:27], s80 offen offset:0
    buffer_load_dwordx4 v[84:87], v40, s[24:27], s80 offen offset:2048
    s_bitcmp0_b32 s84, 4
    s_cbranch_scc1 L_vbad8
L_vgood8:
    s_waitcnt lgkmcnt(1)
    v_mfma_f32_16x16x32_bf16 v[48:51], v[208:211], v[24:27], v[48:51]
    v_perm_b32 v208, v148, v144, s61
    v_mfma_f32_16x16x32_bf16 v[52:55], v[212:215], v[24:27], v[52:55]
    v_perm_b32 v212, v148, v144, s62
    v_mfma_f32_16x16x32_bf16 v[56:59], v[216:219], v[24:27], v[56:59]
    v_perm_b32 v216, v149, v145, s61
    v_mfma_f32_16x16x32_bf16 v[60:63], v[220:223], v[24:27], v[60:63]
    v_perm_b32 v220, v149, v145, s62
    v_mfma_f32_16x16x32_bf16 v[64:67], v[224:227], v[24:27], v[64:67]
    v_perm_b32 v224, v150, v146, s61
    v_mfma_f32_16x16x32_bf16 v[68:71], v[228:231], v[24:27], v[68:71]
    v_perm_b32 v228, v150, v146, s62
    v_mfma_f32_16x16x32_bf16 v[72:75], v[232:235], v[24:27], v[72:75]
    v_perm_b32 v232, v151, v147, s61
    v_mfma_f32_16x16x32_bf16 v[76:79], v[236:239], v[24:27], v[76:79]
    v_perm_b32 v236, v151, v147, s62
    s_waitcnt vmcnt(21)
    buffer_load_dwordx4 v[88:91], v41, s[24:27], s80 offen offset:0
    buffer_load_dwordx4 v[92:95], v41, s[24:27], s80 offen offset:2048
    v_add_u32 v43, 1, v43
    ds_write_b32 v44, v43
    s_bitcmp0_b32 s84, 4
    s_cbranch_scc1 L_vbad9
L_vgood9:
    ds_read_b128 v[24:27], v17 offset:11264
    v_perm_b32 v209, v156, v152, s61
    v_perm_b32 v213, v156, v152, s62
    v_perm_b32 v217, v157, v153, s61
    v_perm_b32 v221, v157, v153, s62
    v_perm_b32 v225, v158, v154, s61
    v_perm_b32 v229, v158, v154, s62
    v_perm_b32 v233, v159, v155, s61
    v_perm_b32 v237, v159, v155, s62
    s_bitcmp1_b32 s84, 9
    s_cselect_b32 s26, s86, 0
    v_readlane_b32 s82, v45, 10
    s_waitcnt vmcnt(21)
    buffer_load_dwordx4 v[96:99], v40, s[24:27], s81 offen offset:0
    buffer_load_dwordx4 v[100:103], v40, s[24:27], s81 offen offset:2048
    s_bitcmp0_b32 s84, 5
    s_cbranch_scc1 L_vbad10
L_vgood10:
    v_perm_b32 v210, v164, v160, s61
    v_perm_b32 v214, v164, v160, s62
    v_perm_b32 v218, v165, v161, s61
    v_perm_b32 v222, v165, v161, s62
    v_perm_b32 v226, v166, v162, s61
    v_perm_b32 v230, v166, v162, s62
    v_perm_b32 v234, v167, v163, s61
    v_perm_b32 v238, v167, v163, s62
    s_waitcnt vmcnt(21)
    buffer_load_dwordx4 v[104:107], v41, s[24:27], s81 offen offset:0
    buffer_load_dwordx4 v[108:111], v41, s[24:27], s81 offen offset:2048
    v_add_u32 v43, 1, v43
    ds_write_b32 v44, v43
    s_bitcmp0_b32 s84, 5
    s_cbranch_scc1 L_vbad11
L_vgood11:
    v_perm_b32 v211, v172, v168, s61
    v_perm_b32 v215, v172, v168, s62
    v_perm_b32 v219, v173, v169, s61
    v_perm_b32 v223, v173, v169, s62
    v_perm_b32 v227, v174, v170, s61
    v_perm_b32 v231, v174, v170, s62
    v_perm_b32 v235, v175, v171, s61
    v_perm_b32 v239, v175, v171, s62
    s_bitcmp1_b32 s84, 10
    s_cselect_b32 s26, s86, 0
    v_readlane_b32 s83, v45, 11
    s_waitcnt vmcnt(21)
    buffer_load_dwordx4 v[112:115], v40, s[24:27], s82 offen offset:0
    buffer_load_dwordx4 v[116:119], v40, s[24:27], s82 offen offset:2048
    s_waitcnt vmcnt(21)
    buffer_load_dwordx4 v[120:123], v41, s[24:27], s82 offen offset:0
    buffer_load_dwordx4 v[124:127], v41, s[24:27], s82 offen offset:2048
    v_add_u32 v43, 1, v43
    ds_write_b32 v44, v43
    s_bitcmp1_b32 s84, 11
    s_cselect_b32 s26, s86, 0
    v_readlane_b32 s80, v45, 12
    s_waitcnt vmcnt(21)
    buffer_load_dwordx4 v[128:131], v40, s[24:27], s83 offen offset:0
    buffer_load_dwordx4 v[132:135], v40, s[24:27], s83 offen offset:2048
    s_waitcnt vmcnt(21)
    buffer_load_dwordx4 v[136:139], v41, s[24:27], s83 offen offset:0
    buffer_load_dwordx4 v[140:143], v41, s[24:27], s83 offen offset:2048
    v_add_u32 v43, 1, v43
    ds_write_b32 v44, v43
    s_bitcmp1_b32 s84, 12
    s_cselect_b32 s26, s86, 0
    v_readlane_b32 s81, v45, 13
    s_waitcnt vmcnt(21)
    buffer_load_dwordx4 v[144:147], v40, s[24:27], s80 offen offset:0
    buffer_load_dwordx4 v[148:151], v40, s[24:27], s80 offen offset:2048
    s_waitcnt lgkmcnt(1)
    v_mfma_f32_16x16x32_bf16 v[48:51], v[208:211], v[20:23], v[48:51]
    v_perm_b32 v208, v180, v176, s61
    v_mfma_f32_16x16x32_bf16 v[52:55], v[212:215], v[20:23], v[52:55]
    v_perm_b32 v212, v180, v176, s62
    v_mfma_f32_16x16x32_bf16 v[56:59], v[216:219], v[20:23], v[56:59]
    v_perm_b32 v216, v181, v177, s61
    v_mfma_f32_16x16x32_bf16 v[60:63], v[220:223], v[20:23], v[60:63]
    v_perm_b32 v220, v181, v177, s62
    v_mfma_f32_16x16x32_bf16 v[64:67], v[224:227], v[20:23], v[64:67]
    v_perm_b32 v224, v182, v178, s61
    v_mfma_f32_16x16x32_bf16 v[68:71], v[228:231], v[20:23], v[68:71]
    v_perm_b32 v228, v182, v178, s62
    v_mfma_f32_16x16x32_bf16 v[72:75], v[232:235], v[20:23], v[72:75]
    v_perm_b32 v232, v183, v179, s61
    v_mfma_f32_16x16x32_bf16 v[76:79], v[236:239], v[20:23], v[76:79]
    v_perm_b32 v236, v183, v179, s62
    s_waitcnt vmcnt(21)
    buffer_load_dwordx4 v[152:155], v41, s[24:27], s80 offen offset:0
    buffer_load_dwordx4 v[156:159], v41, s[24:27], s80 offen offset:2048
    ds_read_b128 v[20:23], v17 offset:12288
    v_perm_b32 v209, v188, v184, s61
    v_perm_b32 v213, v188, v184, s62
    v_perm_b32 v217, v189, v185, s61
    v_perm_b32 v221, v189, v185, s62
    v_perm_b32 v225, v190, v186, s61
    v_perm_b32 v229, v190, v186, s62
    v_perm_b32 v233, v191, v187, s61
    v_perm_b32 v237, v191, v187, s62
    s_bitcmp1_b32 s84, 13
    s_cselect_b32 s26, s86, 0
    v_readlane_b32 s82, v45, 14
    s_waitcnt vmcnt(21)
    buffer_load_dwordx4 v[160:163], v40, s[24:27], s81 offen offset:0
    buffer_load_dwordx4 v[164:167], v40, s[24:27], s81 offen offset:2048
    v_perm_b32 v210, v196, v192, s61
    v_perm_b32 v214, v196, v192, s62
    v_perm_b32 v218, v197, v193, s61
    v_perm_b32 v222, v197, v193, s62
    v_perm_b32 v226, v198, v194, s61
    v_perm_b32 v230, v198, v194, s62
    v_perm_b32 v234, v199, v195, s61
    v_perm_b32 v238, v199, v195, s62
    s_waitcnt vmcnt(21)
    buffer_load_dwordx4 v[168:171], v41, s[24:27], s81 offen offset:0
    buffer_load_dwordx4 v[172:175], v41, s[24:27], s81 offen offset:2048
    v_perm_b32 v211, v204, v200, s61
    v_perm_b32 v215, v204, v200, s62
    v_perm_b32 v219, v205, v201, s61
    v_perm_b32 v223, v205, v201, s62
    v_perm_b32 v227, v206, v202, s61
    v_perm_b32 v231, v206, v202, s62
    v_perm_b32 v235, v207, v203, s61
    v_perm_b32 v239, v207, v203, s62
    s_bitcmp1_b32 s84, 14
    s_cselect_b32 s26, s86, 0
    v_readlane_b32 s83, v45, 15
    s_waitcnt vmcnt(21)
    buffer_load_dwordx4 v[176:179], v40, s[24:27], s82 offen offset:0
    buffer_load_dwordx4 v[180:183], v40, s[24:27], s82 offen offset:2048
    s_waitcnt lgkmcnt(1)
    v_mfma_f32_16x16x32_bf16 v[48:51], v[208:211], v[24:27], v[48:51]
    v_perm_b32 v208, v84, v80, s61
    v_mfma_f32_16x16x32_bf16 v[52:55], v[212:215], v[24:27], v[52:55]
    v_perm_b32 v212, v84, v80, s62
    v_mfma_f32_16x16x32_bf16 v[56:59], v[216:219], v[24:27], v[56:59]
    v_perm_b32 v216, v85, v81, s61
    v_mfma_f32_16x16x32_bf16 v[60:63], v[220:223], v[24:27], v[60:63]
    v_perm_b32 v220, v85, v81, s62
    v_mfma_f32_16x16x32_bf16 v[64:67], v[224:227], v[24:27], v[64:67]
    v_perm_b32 v224, v86, v82, s61
    v_mfma_f32_16x16x32_bf16 v[68:71], v[228:231], v[24:27], v[68:71]
    v_perm_b32 v228, v86, v82, s62
    v_mfma_f32_16x16x32_bf16 v[72:75], v[232:235], v[24:27], v[72:75]
    v_perm_b32 v232, v87, v83, s61
    v_mfma_f32_16x16x32_bf16 v[76:79], v[236:239], v[24:27], v[76:79]
    v_perm_b32 v236, v87, v83, s62
    s_waitcnt vmcnt(21)
    buffer_load_dwordx4 v[184:187], v41, s[24:27], s82 offen offset:0
    buffer_load_dwordx4 v[188:191], v41, s[24:27], s82 offen offset:2048
    ds_read_b128 v[24:27], v17 offset:13312
    v_perm_b32 v209, v92, v88, s61
    v_perm_b32 v213, v92, v88, s62
    v_perm_b32 v217, v93, v89, s61
    v_perm_b32 v221, v93, v89, s62
    v_perm_b32 v225, v94, v90, s61
    v_perm_b32 v229, v94, v90, s62
    v_perm_b32 v233, v95, v91, s61
    v_perm_b32 v237, v95, v91, s62
    s_bitcmp1_b32 s84, 15
    s_cselect_b32 s26, s86, 0
    v_readlane_b32 s80, v45, 16
    s_waitcnt vmcnt(21)
    buffer_load_dwordx4 v[192:195], v40, s[24:27], s83 offen offset:0
    buffer_load_dwordx4 v[196:199], v40, s[24:27], s83 offen offset:2048
    v_perm_b32 v210, v100, v96, s61
    v_perm_b32 v214, v100, v96, s62
    v_perm_b32 v218, v101, v97, s61
    v_perm_b32 v222, v101, v97, s62
    v_perm_b32 v226, v102, v98, s61
    v_perm_b32 v230, v102, v98, s62
    v_perm_b32 v234, v103, v99, s61
    v_perm_b32 v238, v103, v99, s62
    s_waitcnt vmcnt(21)
    buffer_load_dwordx4 v[200:203], v41, s[24:27], s83 offen offset:0
    buffer_load_dwordx4 v[204:207], v41, s[24:27], s83 offen offset:2048
    v_perm_b32 v211, v108, v104, s61
    v_perm_b32 v215, v108, v104, s62
    v_perm_b32 v219, v109, v105, s61
    v_perm_b32 v223, v109, v105, s62
    v_perm_b32 v227, v110, v106, s61
    v_perm_b32 v231, v110, v106, s62
    v_perm_b32 v235, v111, v107, s61
    v_perm_b32 v239, v111, v107, s62
    s_bitcmp1_b32 s84, 16
    s_cselect_b32 s26, s86, 0
    v_readlane_b32 s81, v45, 17
    s_waitcnt vmcnt(21)
    buffer_load_dwordx4 v[80:83], v40, s[24:27], s80 offen offset:0
    buffer_load_dwordx4 v[84:87], v40, s[24:27], s80 offen offset:2048
    s_waitcnt lgkmcnt(1)
    v_mfma_f32_16x16x32_bf16 v[48:51], v[208:211], v[20:23], v[48:51]
    v_perm_b32 v208, v116, v112, s61
    v_mfma_f32_16x16x32_bf16 v[52:55], v[212:215], v[20:23], v[52:55]
    v_perm_b32 v212, v116, v112, s62
    v_mfma_f32_16x16x32_bf16 v[56:59], v[216:219], v[20:23], v[56:59]
    v_perm_b32 v216, v117, v113, s61
    v_mfma_f32_16x16x32_bf16 v[60:63], v[220:223], v[20:23], v[60:63]
    v_perm_b32 v220, v117, v113, s62
    v_mfma_f32_16x16x32_bf16 v[64:67], v[224:227], v[20:23], v[64:67]
    v_perm_b32 v224, v118, v114, s61
    v_mfma_f32_16x16x32_bf16 v[68:71], v[228:231], v[20:23], v[68:71]
    v_perm_b32 v228, v118, v114, s62
    v_mfma_f32_16x16x32_bf16 v[72:75], v[232:235], v[20:23], v[72:75]
    v_perm_b32 v232, v119, v115, s61
    v_mfma_f32_16x16x32_bf16 v[76:79], v[236:239], v[20:23], v[76:79]
    v_perm_b32 v236, v119, v115, s62
    s_waitcnt vmcnt(21)
    buffer_load_dwordx4 v[88:91], v41, s[24:27], s80 offen offset:0
    buffer_load_dwordx4 v[92:95], v41, s[24:27], s80 offen offset:2048
    ds_read_b128 v[20:23], v17 offset:14336
    v_perm_b32 v209, v124, v120, s61
    v_perm_b32 v213, v124, v120, s62
    v_perm_b32 v217, v125, v121, s61
    v_perm_b32 v221, v125, v121, s62
    v_perm_b32 v225, v126, v122, s61
    v_perm_b32 v229, v126, v122, s62
    v_perm_b32 v233, v127, v123, s61
    v_perm_b32 v237, v127, v123, s62
    s_bitcmp1_b32 s84, 17
    s_cselect_b32 s26, s86, 0
    v_readlane_b32 s82, v45, 18
    s_waitcnt vmcnt(21)
    buffer_load_dwordx4 v[96:99], v40, s[24:27], s81 offen offset:0
    buffer_load_dwordx4 v[100:103], v40, s[24:27], s81 offen offset:2048
    v_perm_b32 v210, v132, v128, s61
    v_perm_b32 v214, v132, v128, s62
    v_perm_b32 v218, v133, v129, s61
    v_perm_b32 v222, v133, v129, s62
    v_perm_b32 v226, v134, v130, s61
    v_perm_b32 v230, v134, v130, s62
    v_perm_b32 v234, v135, v131, s61
    v_perm_b32 v238, v135, v131, s62
    s_waitcnt vmcnt(21)
    buffer_load_dwordx4 v[104:107], v41, s[24:27], s81 offen offset:0
    buffer_load_dwordx4 v[108:111], v41, s[24:27], s81 offen offset:2048
    v_perm_b32 v211, v140, v136, s61
    v_perm_b32 v215, v140, v136, s62
    v_perm_b32 v219, v141, v137, s61
    v_perm_b32 v223, v141, v137, s62
    v_perm_b32 v227, v142, v138, s61
    v_perm_b32 v231, v142, v138, s62
    v_perm_b32 v235, v143, v139, s61
    v_perm_b32 v239, v143, v139, s62
    s_bitcmp1_b32 s84, 18
    s_cselect_b32 s26, s86, 0
    v_readlane_b32 s83, v45, 19
    s_waitcnt vmcnt(21)
    buffer_load_dwordx4 v[112:115], v40, s[24:27], s82 offen offset:0
    buffer_load_dwordx4 v[116:119], v40, s[24:27], s82 offen offset:2048
    s_waitcnt lgkmcnt(1)
    v_mfma_f32_16x16x32_bf16 v[48:51], v[208:211], v[24:27], v[48:51]
    v_perm_b32 v208, v148, v144, s61
    v_mfma_f32_16x16x32_bf16 v[52:55], v[212:215], v[24:27], v[52:55]
    v_perm_b32 v212, v148, v144, s62
    v_mfma_f32_16x16x32_bf16 v[56:59], v[216:219], v[24:27], v[56:59]
    v_perm_b32 v216, v149, v145, s61
    v_mfma_f32_16x16x32_bf16 v[60:63], v[220:223], v[24:27], v[60:63]
    v_perm_b32 v220, v149, v145, s62
    v_mfma_f32_16x16x32_bf16 v[64:67], v[224:227], v[24:27], v[64:67]
    v_perm_b32 v224, v150, v146, s61
    v_mfma_f32_16x16x32_bf16 v[68:71], v[228:231], v[24:27], v[68:71]
    v_perm_b32 v228, v150, v146, s62
    v_mfma_f32_16x16x32_bf16 v[72:75], v[232:235], v[24:27], v[72:75]
    v_perm_b32 v232, v151, v147, s61
    v_mfma_f32_16x16x32_bf16 v[76:79], v[236:239], v[24:27], v[76:79]
    v_perm_b32 v236, v151, v147, s62
    s_waitcnt vmcnt(21)
    buffer_load_dwordx4 v[120:123], v41, s[24:27], s82 offen offset:0
    buffer_load_dwordx4 v[124:127], v41, s[24:27], s82 offen offset:2048
    ds_read_b128 v[24:27], v17 offset:15360
    v_perm_b32 v209, v156, v152, s61
    v_perm_b32 v213, v156, v152, s62
    v_perm_b32 v217, v157, v153, s61
    v_perm_b32 v221, v157, v153, s62
    v_perm_b32 v225, v158, v154, s61
    v_perm_b32 v229, v158, v154, s62
    v_perm_b32 v233, v159, v155, s61
    v_perm_b32 v237, v159, v155, s62
    s_bitcmp1_b32 s84, 19
    s_cselect_b32 s26, s86, 0
    v_readlane_b32 s80, v45, 20
    s_waitcnt vmcnt(21)
    buffer_load_dwordx4 v[128:131], v40, s[24:27], s83 offen offset:0
    buffer_load_dwordx4 v[132:135], v40, s[24:27], s83 offen offset:2048
    v_perm_b32 v210, v164, v160, s61
    v_perm_b32 v214, v164, v160, s62
    v_perm_b32 v218, v165, v161, s61
    v_perm_b32 v222, v165, v161, s62
    v_perm_b32 v226, v166, v162, s61
    v_perm_b32 v230, v166, v162, s62
    v_perm_b32 v234, v167, v163, s61
    v_perm_b32 v238, v167, v163, s62
    s_waitcnt vmcnt(21)
    buffer_load_dwordx4 v[136:139], v41, s[24:27], s83 offen offset:0
    buffer_load_dwordx4 v[140:143], v41, s[24:27], s83 offen offset:2048
    v_perm_b32 v211, v172, v168, s61
    v_perm_b32 v215, v172, v168, s62
    v_perm_b32 v219, v173, v169, s61
    v_perm_b32 v223, v173, v169, s62
    v_perm_b32 v227, v174, v170, s61
    v_perm_b32 v231, v174, v170, s62
    v_perm_b32 v235, v175, v171, s61
    v_perm_b32 v239, v175, v171, s62
    s_bitcmp1_b32 s84, 20
    s_cselect_b32 s26, s86, 0
    v_readlane_b32 s81, v45, 21
    s_waitcnt vmcnt(21)
    buffer_load_dwordx4 v[144:147], v40, s[24:27], s80 offen offset:0
    buffer_load_dwordx4 v[148:151], v40, s[24:27], s80 offen offset:2048
    s_waitcnt lgkmcnt(1)
    v_mfma_f32_16x16x32_bf16 v[48:51], v[208:211], v[20:23], v[48:51]
    v_perm_b32 v208, v180, v176, s61
    v_mfma_f32_16x16x32_bf16 v[52:55], v[212:215], v[20:23], v[52:55]
    v_perm_b32 v212, v180, v176, s62
    v_mfma_f32_16x16x32_bf16 v[56:59], v[216:219], v[20:23], v[56:59]
    v_perm_b32 v216, v181, v177, s61
    v_mfma_f32_16x16x32_bf16 v[60:63], v[220:223], v[20:23], v[60:63]
    v_perm_b32 v220, v181, v177, s62
    v_mfma_f32_16x16x32_bf16 v[64:67], v[224:227], v[20:23], v[64:67]
    v_perm_b32 v224, v182, v178, s61
    v_mfma_f32_16x16x32_bf16 v[68:71], v[228:231], v[20:23], v[68:71]
    v_perm_b32 v228, v182, v178, s62
    v_mfma_f32_16x16x32_bf16 v[72:75], v[232:235], v[20:23], v[72:75]
    v_perm_b32 v232, v183, v179, s61
    v_mfma_f32_16x16x32_bf16 v[76:79], v[236:239], v[20:23], v[76:79]
    v_perm_b32 v236, v183, v179, s62
    s_waitcnt vmcnt(21)
    buffer_load_dwordx4 v[152:155], v41, s[24:27], s80 offen offset:0
    buffer_load_dwordx4 v[156:159], v41, s[24:27], s80 offen offset:2048
    v_perm_b32 v209, v188, v184, s61
    v_perm_b32 v213, v188, v184, s62
    v_perm_b32 v217, v189, v185, s61
    v_perm_b32 v221, v189, v185, s62
    v_perm_b32 v225, v190, v186, s61
    v_perm_b32 v229, v190, v186, s62
    v_perm_b32 v233, v191, v187, s61
    v_perm_b32 v237, v191, v187, s62
    s_bitcmp1_b32 s84, 21
    s_cselect_b32 s26, s86, 0
    v_readlane_b32 s82, v45, 22
    s_waitcnt vmcnt(21)
    buffer_load_dwordx4 v[160:163], v40, s[24:27], s81 offen offset:0
    buffer_load_dwordx4 v[164:167], v40, s[24:27], s81 offen offset:2048
    ds_read_b32 v6, v15 offset:3076
    ds_read_b128 v[20:23], v17 offset:16384
    ds_read_b32 v4, v44 offset:512
    ds_read_b32 v19, v15 offset:3104
    v_perm_b32 v210, v196, v192, s61
    v_perm_b32 v214, v196, v192, s62
    v_perm_b32 v218, v197, v193, s61
    v_perm_b32 v222, v197, v193, s62
    v_perm_b32 v226, v198, v194, s61
    v_perm_b32 v230, v198, v194, s62
    v_perm_b32 v234, v199, v195, s61
    v_perm_b32 v238, v199, v195, s62
    s_waitcnt vmcnt(21)
    buffer_load_dwordx4 v[168:171], v41, s[24:27], s81 offen offset:0
    buffer_load_dwordx4 v[172:175], v41, s[24:27], s81 offen offset:2048
    v_perm_b32 v211, v204, v200, s61
    v_perm_b32 v215, v204, v200, s62
    v_perm_b32 v219, v205, v201, s61
    v_perm_b32 v223, v205, v201, s62
    v_perm_b32 v227, v206, v202, s61
    v_perm_b32 v231, v206, v202, s62
    v_perm_b32 v235, v207, v203, s61
    v_perm_b32 v239, v207, v203, s62
    s_bitcmp1_b32 s84, 22
    s_cselect_b32 s26, s86, 0
    v_readlane_b32 s83, v45, 23
    s_waitcnt vmcnt(21)
    buffer_load_dwordx4 v[176:179], v40, s[24:27], s82 offen offset:0
    buffer_load_dwordx4 v[180:183], v40, s[24:27], s82 offen offset:2048
    s_waitcnt lgkmcnt(4)
    v_mfma_f32_16x16x32_bf16 v[48:51], v[208:211], v[24:27], v[48:51]
    v_perm_b32 v208, v84, v80, s61
    v_mfma_f32_16x16x32_bf16 v[52:55], v[212:215], v[24:27], v[52:55]
    v_perm_b32 v212, v84, v80, s62
    v_mfma_f32_16x16x32_bf16 v[56:59], v[216:219], v[24:27], v[56:59]
    v_perm_b32 v216, v85, v81, s61
    v_mfma_f32_16x16x32_bf16 v[60:63], v[220:223], v[24:27], v[60:63]
    v_perm_b32 v220, v85, v81, s62
    v_mfma_f32_16x16x32_bf16 v[64:67], v[224:227], v[24:27], v[64:67]
    v_perm_b32 v224, v86, v82, s61
    v_mfma_f32_16x16x32_bf16 v[68:71], v[228:231], v[24:27], v[68:71]
    v_perm_b32 v228, v86, v82, s62
    v_mfma_f32_16x16x32_bf16 v[72:75], v[232:235], v[24:27], v[72:75]
    v_perm_b32 v232, v87, v83, s61
    v_mfma_f32_16x16x32_bf16 v[76:79], v[236:239], v[24:27], v[76:79]
    v_perm_b32 v236, v87, v83, s62
    s_waitcnt vmcnt(21)
    buffer_load_dwordx4 v[184:187], v41, s[24:27], s82 offen offset:0
    buffer_load_dwordx4 v[188:191], v41, s[24:27], s82 offen offset:2048
    s_nop 7
    s_waitcnt lgkmcnt(0)
    v_cmp_gt_u32 vcc, s63, v6
    s_cbranch_vccnz L_pagain1
L_pok1:
    s_add_u32 s63, s63, 4
    v_readfirstlane_b32 s41, v19
    v_pk_mul_f32 v[48:49], v[48:49], v[4:5] op_sel_hi:[1,0]
    v_pk_mul_f32 v[50:51], v[50:51], v[4:5] op_sel_hi:[1,0]
    v_pk_mul_f32 v[52:53], v[52:53], v[4:5] op_sel_hi:[1,0]
    v_pk_mul_f32 v[54:55], v[54:55], v[4:5] op_sel_hi:[1,0]
    v_pk_mul_f32 v[56:57], v[56:57], v[4:5] op_sel_hi:[1,0]
    v_pk_mul_f32 v[58:59], v[58:59], v[4:5] op_sel_hi:[1,0]
    v_pk_mul_f32 v[60:61], v[60:61], v[4:5] op_sel_hi:[1,0]
    v_pk_mul_f32 v[62:63], v[62:63], v[4:5] op_sel_hi:[1,0]
    v_pk_mul_f32 v[64:65], v[64:65], v[4:5] op_sel_hi:[1,0]
    v_pk_mul_f32 v[66:67], v[66:67], v[4:5] op_sel_hi:[1,0]
    v_pk_mul_f32 v[68:69], v[68:69], v[4:5] op_sel_hi:[1,0]
    v_pk_mul_f32 v[70:71], v[70:71], v[4:5] op_sel_hi:[1,0]
    v_pk_mul_f32 v[72:73], v[72:73], v[4:5] op_sel_hi:[1,0]
    v_pk_mul_f32 v[74:75], v[74:75], v[4:5] op_sel_hi:[1,0]
    v_pk_mul_f32 v[76:77], v[76:77], v[4:5] op_sel_hi:[1,0]
    v_pk_mul_f32 v[78:79], v[78:79], v[4:5] op_sel_hi:[1,0]
    s_mov_b64 vcc, s[90:91]
    ds_read_b128 v[24:27], v17 offset:17408
    v_perm_b32 v209, v92, v88, s61
    v_perm_b32 v213, v92, v88, s62
    v_perm_b32 v217, v93, v89, s61
    v_perm_b32 v221, v93, v89, s62
    v_perm_b32 v225, v94, v90, s61
    v_perm_b32 v229, v94, v90, s62
    v_perm_b32 v233, v95, v91, s61
    v_perm_b32 v237, v95, v91, s62
    s_bitcmp1_b32 s84, 23
    s_cselect_b32 s26, s86, 0
    v_readlane_b32 s80, v45, 24
    s_waitcnt vmcnt(21)
    buffer_load_dwordx4 v[192:195], v40, s[24:27], s83 offen offset:0
    buffer_load_dwordx4 v[196:199], v40, s[24:27], s83 offen offset:2048
    v_perm_b32 v210, v100, v96, s61
    v_perm_b32 v214, v100, v96, s62
    v_perm_b32 v218, v101, v97, s61
    v_perm_b32 v222, v101, v97, s62
    v_perm_b32 v226, v102, v98, s61
    v_perm_b32 v230, v102, v98, s62
    v_perm_b32 v234, v103, v99, s61
    v_perm_b32 v238, v103, v99, s62
    s_waitcnt vmcnt(21)
    buffer_load_dwordx4 v[200:203], v41, s[24:27], s83 offen offset:0
    buffer_load_dwordx4 v[204:207], v41, s[24:27], s83 offen offset:2048
    v_perm_b32 v211, v108, v104, s61
    v_perm_b32 v215, v108, v104, s62
    v_perm_b32 v219, v109, v105, s61
    v_perm_b32 v223, v109, v105, s62
    v_perm_b32 v227, v110, v106, s61
    v_perm_b32 v231, v110, v106, s62
    v_perm_b32 v235, v111, v107, s61
    v_perm_b32 v239, v111, v107, s62
    s_bitcmp1_b32 s84, 24
    s_cselect_b32 s26, s86, 0
    v_readlane_b32 s81, v45, 25
    s_waitcnt vmcnt(28)
    buffer_load_dwordx4 v[80:83], v40, s[24:27], s80 offen offset:0
    buffer_load_dwordx4 v[84:87], v40, s[24:27], s80 offen offset:2048
    s_waitcnt vmcnt(28)
    buffer_load_dwordx4 v[88:91], v41, s[24:27], s80 offen offset:0
    buffer_load_dwordx4 v[92:95], v41, s[24:27], s80 offen offset:2048
    s_bitcmp1_b32 s84, 25
    s_cselect_b32 s26, s86, 0
    v_readlane_b32 s82, v45, 26
    s_waitcnt vmcnt(28)
    buffer_load_dwordx4 v[96:99], v40, s[24:27], s81 offen offset:0
    buffer_load_dwordx4 v[100:103], v40, s[24:27], s81 offen offset:2048
    s_waitcnt vmcnt(28)
    buffer_load_dwordx4 v[104:107], v41, s[24:27], s81 offen offset:0
    buffer_load_dwordx4 v[108:111], v41, s[24:27], s81 offen offset:2048
    v_mfma_f32_16x16x32_bf16 v[48:51], v[208:211], v[20:23], v[48:51]
    v_perm_b32 v208, v116, v112, s61
    v_mfma_f32_16x16x32_bf16 v[52:55], v[212:215], v[20:23], v[52:55]
    v_perm_b32 v212, v116, v112, s62
    v_mfma_f32_16x16x32_bf16 v[56:59], v[216:219], v[20:23], v[56:59]
    v_perm_b32 v216, v117, v113, s61
    v_mfma_f32_16x16x32_bf16 v[60:63], v[220:223], v[20:23], v[60:63]
    v_perm_b32 v220, v117, v113, s62
    v_mfma_f32_16x16x32_bf16 v[64:67], v[224:227], v[20:23], v[64:67]
    v_perm_b32 v224, v118, v114, s61
    v_mfma_f32_16x16x32_bf16 v[68:71], v[228:231], v[20:23], v[68:71]
    v_perm_b32 v228, v118, v114, s62
    v_mfma_f32_16x16x32_bf16 v[72:75], v[232:235], v[20:23], v[72:75]
    v_perm_b32 v232, v119, v115, s61
    v_mfma_f32_16x16x32_bf16 v[76:79], v[236:239], v[20:23], v[76:79]
    v_perm_b32 v236, v119, v115, s62
    s_bitcmp1_b32 s84, 26
    s_cselect_b32 s26, s86, 0
    v_readlane_b32 s83, v45, 27
    s_waitcnt vmcnt(28)
    buffer_load_dwordx4 v[112:115], v40, s[24:27], s82 offen offset:0
    buffer_load_dwordx4 v[116:119], v40, s[24:27], s82 offen offset:2048
    ds_read_b128 v[20:23], v17 offset:18432
    v_perm_b32 v209, v124, v120, s61
    v_perm_b32 v213, v124, v120, s62
    v_perm_b32 v217, v125, v121, s61
    v_perm_b32 v221, v125, v121, s62
    v_perm_b32 v225, v126, v122, s61
    v_perm_b32 v229, v126, v122, s62
    v_perm_b32 v233, v127, v123, s61
    v_perm_b32 v237, v127, v123, s62
    s_waitcnt vmcnt(28)
    buffer_load_dwordx4 v[120:123], v41, s[24:27], s82 offen offset:0
    buffer_load_dwordx4 v[124:127], v41, s[24:27], s82 offen offset:2048
    v_perm_b32 v210, v132, v128, s61
    v_perm_b32 v214, v132, v128, s62
    v_perm_b32 v218, v133, v129, s61
    v_perm_b32 v222, v133, v129, s62
    v_perm_b32 v226, v134, v130, s61
    v_perm_b32 v230, v134, v130, s62
    v_perm_b32 v234, v135, v131, s61
    v_perm_b32 v238, v135, v131, s62
    s_bitcmp1_b32 s84, 27
    s_cselect_b32 s26, s86, 0
    v_readlane_b32 s80, v45, 28
    s_waitcnt vmcnt(28)
    buffer_load_dwordx4 v[128:131], v40, s[24:27], s83 offen offset:0
    buffer_load_dwordx4 v[132:135], v40, s[24:27], s83 offen offset:2048
    v_perm_b32 v211, v140, v136, s61
    v_perm_b32 v215, v140, v136, s62
    v_perm_b32 v219, v141, v137, s61
    v_perm_b32 v223, v141, v137, s62
    v_perm_b32 v227, v142, v138, s61
    v_perm_b32 v231, v142, v138, s62
    v_perm_b32 v235, v143, v139, s61
    v_perm_b32 v239, v143, v139, s62
    s_waitcnt vmcnt(28)
    buffer_load_dwordx4 v[136:139], v41, s[24:27], s83 offen offset:0
    buffer_load_dwordx4 v[140:143], v41, s[24:27], s83 offen offset:2048
    s_waitcnt lgkmcnt(1)
    v_mfma_f32_16x16x32_bf16 v[48:51], v[208:211], v[24:27], v[48:51]
    v_perm_b32 v208, v148, v144, s61
    v_mfma_f32_16x16x32_bf16 v[52:55], v[212:215], v[24:27], v[52:55]
    v_perm_b32 v212, v148, v144, s62
    v_mfma_f32_16x16x32_bf16 v[56:59], v[216:219], v[24:27], v[56:59]
    v_perm_b32 v216, v149, v145, s61
    v_mfma_f32_16x16x32_bf16 v[60:63], v[220:223], v[24:27], v[60:63]
    v_perm_b32 v220, v149, v145, s62
    v_mfma_f32_16x16x32_bf16 v[64:67], v[224:227], v[24:27], v[64:67]
    v_perm_b32 v224, v150, v146, s61
    v_mfma_f32_16x16x32_bf16 v[68:71], v[228:231], v[24:27], v[68:71]
    v_perm_b32 v228, v150, v146, s62
    v_mfma_f32_16x16x32_bf16 v[72:75], v[232:235], v[24:27], v[72:75]
    v_perm_b32 v232, v151, v147, s61
    v_mfma_f32_16x16x32_bf16 v[76:79], v[236:239], v[24:27], v[76:79]
    v_perm_b32 v236, v151, v147, s62
    s_bitcmp1_b32 s84, 28
    s_cselect_b32 s26, s86, 0
    v_readlane_b32 s81, v45, 29
    s_waitcnt vmcnt(28)
    buffer_load_dwordx4 v[144:147], v40, s[24:27], s80 offen offset:0
    buffer_load_dwordx4 v[148:151], v40, s[24:27], s80 offen offset:2048
    ds_read_b128 v[24:27], v17 offset:19456
    v_perm_b32 v209, v156, v152, s61
    v_perm_b32 v213, v156, v152, s62
    v_perm_b32 v217, v157, v153, s61
    v_perm_b32 v221, v157, v153, s62
    v_perm_b32 v225, v158, v154, s61
    v_perm_b32 v229, v158, v154, s62
    v_perm_b32 v233, v159, v155, s61
    v_perm_b32 v237, v159, v155, s62
    s_waitcnt vmcnt(28)
    buffer_load_dwordx4 v[152:155], v41, s[24:27], s80 offen offset:0
    buffer_load_dwordx4 v[156:159], v41, s[24:27], s80 offen offset:2048
    v_perm_b32 v210, v164, v160, s61
    v_perm_b32 v214, v164, v160, s62
    v_perm_b32 v218, v165, v161, s61
    v_perm_b32 v222, v165, v161, s62
    v_perm_b32 v226, v166, v162, s61
    v_perm_b32 v230, v166, v162, s62
    v_perm_b32 v234, v167, v163, s61
    v_perm_b32 v238, v167, v163, s62
    s_bitcmp1_b32 s84, 29
    s_cselect_b32 s26, s86, 0
    v_readlane_b32 s82, v45, 30
    s_waitcnt vmcnt(28)
    buffer_load_dwordx4 v[160:163], v40, s[24:27], s81 offen offset:0
    buffer_load_dwordx4 v[164:167], v40, s[24:27], s81 offen offset:2048
    v_perm_b32 v211, v172, v168, s61
    v_perm_b32 v215, v172, v168, s62
    v_perm_b32 v219, v173, v169, s61
    v_perm_b32 v223, v173, v169, s62
    v_perm_b32 v227, v174, v170, s61
    v_perm_b32 v231, v174, v170, s62
    v_perm_b32 v235, v175, v171, s61
    v_perm_b32 v239, v175, v171, s62
    s_waitcnt vmcnt(28)
    buffer_load_dwordx4 v[168:171], v41, s[24:27], s81 offen offset:0
    buffer_load_dwordx4 v[172:175], v41, s[24:27], s81 offen offset:2048
    s_waitcnt lgkmcnt(1)
    v_mfma_f32_16x16x32_bf16 v[48:51], v[208:211], v[20:23], v[48:51]
    v_perm_b32 v208, v180, v176, s61
    v_mfma_f32_16x16x32_bf16 v[52:55], v[212:215], v[20:23], v[52:55]
    v_perm_b32 v212, v180, v176, s62
    v_mfma_f32_16x16x32_bf16 v[56:59], v[216:219], v[20:23], v[56:59]
    v_perm_b32 v216, v181, v177, s61
    v_mfma_f32_16x16x32_bf16 v[60:63], v[220:223], v[20:23], v[60:63]
    v_perm_b32 v220, v181, v177, s62
    v_mfma_f32_16x16x32_bf16 v[64:67], v[224:227], v[20:23], v[64:67]
    v_perm_b32 v224, v182, v178, s61
    v_mfma_f32_16x16x32_bf16 v[68:71], v[228:231], v[20:23], v[68:71]
    v_perm_b32 v228, v182, v178, s62
    v_mfma_f32_16x16x32_bf16 v[72:75], v[232:235], v[20:23], v[72:75]
    v_perm_b32 v232, v183, v179, s61
    v_mfma_f32_16x16x32_bf16 v[76:79], v[236:239], v[20:23], v[76:79]
    v_perm_b32 v236, v183, v179, s62
    s_bitcmp1_b32 s84, 30
    s_cselect_b32 s26, s86, 0
    v_readlane_b32 s83, v45, 31
    s_waitcnt vmcnt(28)
    buffer_load_dwordx4 v[176:179], v40, s[24:27], s82 offen offset:0
    buffer_load_dwordx4 v[180:183], v40, s[24:27], s82 offen offset:2048
    ds_read_b128 v[20:23], v17 offset:20480
    v_perm_b32 v209, v188, v184, s61
    v_perm_b32 v213, v188, v184, s62
    v_perm_b32 v217, v189, v185, s61
    v_perm_b32 v221, v189, v185, s62
    v_perm_b32 v225, v190, v186, s61
    v_perm_b32 v229, v190, v186, s62
    v_perm_b32 v233, v191, v187, s61
    v_perm_b32 v237, v191, v187, s62
    s_waitcnt vmcnt(28)
    buffer_load_dwordx4 v[184:187], v41, s[24:27], s82 offen offset:0
    buffer_load_dwordx4 v[188:191], v41, s[24:27], s82 offen offset:2048
    v_perm_b32 v210, v196, v192, s61
    v_perm_b32 v214, v196, v192, s62
    v_perm_b32 v218, v197, v193, s61
    v_perm_b32 v222, v197, v193, s62
    v_perm_b32 v226, v198, v194, s61
    v_perm_b32 v230, v198, v194, s62
    v_perm_b32 v234, v199, v195, s61
    v_perm_b32 v238, v199, v195, s62
    s_bitcmp1_b32 s84, 31
    s_cselect_b32 s26, s86, 0
    s_waitcnt vmcnt(28)
    buffer_load_dwordx4 v[192:195], v40, s[24:27], s83 offen offset:0
    buffer_load_dwordx4 v[196:199], v40, s[24:27], s83 offen offset:2048
    v_perm_b32 v211, v204, v200, s61
    v_perm_b32 v215, v204, v200, s62
    v_perm_b32 v219, v205, v201, s61
    v_perm_b32 v223, v205, v201, s62
    v_perm_b32 v227, v206, v202, s61
    v_perm_b32 v231, v206, v202, s62
    v_perm_b32 v235, v207, v203, s61
    v_perm_b32 v239, v207, v203, s62
    s_waitcnt vmcnt(28)
    buffer_load_dwordx4 v[200:203], v41, s[24:27], s83 offen offset:0
    buffer_load_dwordx4 v[204:207], v41, s[24:27], s83 offen offset:2048
    s_waitcnt lgkmcnt(1)
    v_mfma_f32_16x16x32_bf16 v[48:51], v[208:211], v[24:27], v[48:51]
    v_perm_b32 v208, v84, v80, s61
    v_mfma_f32_16x16x32_bf16 v[52:55], v[212:215], v[24:27], v[52:55]
    v_perm_b32 v212, v84, v80, s62
    v_mfma_f32_16x16x32_bf16 v[56:59], v[216:219], v[24:27], v[56:59]
    v_perm_b32 v216, v85, v81, s61
    v_mfma_f32_16x16x32_bf16 v[60:63], v[220:223], v[24:27], v[60:63]
    v_perm_b32 v220, v85, v81, s62
    v_mfma_f32_16x16x32_bf16 v[64:67], v[224:227], v[24:27], v[64:67]
    v_perm_b32 v224, v86, v82, s61
    v_mfma_f32_16x16x32_bf16 v[68:71], v[228:231], v[24:27], v[68:71]
    v_perm_b32 v228, v86, v82, s62
    v_mfma_f32_16x16x32_bf16 v[72:75], v[232:235], v[24:27], v[72:75]
    v_perm_b32 v232, v87, v83, s61
    v_mfma_f32_16x16x32_bf16 v[76:79], v[236:239], v[24:27], v[76:79]
    v_perm_b32 v236, v87, v83, s62
    v_mov_b32 v7, 1
    s_mov_b64 exec, 1
    ds_add_u32 v15, v7 offset:3084
    s_mov_b64 exec, -1
    s_waitcnt vmcnt(28)
    ds_read_b128 v[24:27], v17 offset:21504
    v_perm_b32 v209, v92, v88, s61
    v_perm_b32 v213, v92, v88, s62
    v_perm_b32 v217, v93, v89, s61
    v_perm_b32 v221, v93, v89, s62
    v_perm_b32 v225, v94, v90, s61
    v_perm_b32 v229, v94, v90, s62
    v_perm_b32 v233, v95, v91, s61
    v_perm_b32 v237, v95, v91, s62
    s_waitcnt vmcnt(26)
    v_perm_b32 v210, v100, v96, s61
    v_perm_b32 v214, v100, v96, s62
    v_perm_b32 v218, v101, v97, s61
    v_perm_b32 v222, v101, v97, s62
    v_perm_b32 v226, v102, v98, s61
    v_perm_b32 v230, v102, v98, s62
    v_perm_b32 v234, v103, v99, s61
    v_perm_b32 v238, v103, v99, s62
    s_waitcnt vmcnt(24)
    v_perm_b32 v211, v108, v104, s61
    v_perm_b32 v215, v108, v104, s62
    v_perm_b32 v219, v109, v105, s61
    v_perm_b32 v223, v109, v105, s62
    v_perm_b32 v227, v110, v106, s61
    v_perm_b32 v231, v110, v106, s62
    v_perm_b32 v235, v111, v107, s61
    v_perm_b32 v239, v111, v107, s62
    s_waitcnt vmcnt(22)
    s_waitcnt lgkmcnt(1)
    v_mfma_f32_16x16x32_bf16 v[48:51], v[208:211], v[20:23], v[48:51]
    v_perm_b32 v208, v116, v112, s61
    v_mfma_f32_16x16x32_bf16 v[52:55], v[212:215], v[20:23], v[52:55]
    v_perm_b32 v212, v116, v112, s62
    v_mfma_f32_16x16x32_bf16 v[56:59], v[216:219], v[20:23], v[56:59]
    v_perm_b32 v216, v117, v113, s61
    v_mfma_f32_16x16x32_bf16 v[60:63], v[220:223], v[20:23], v[60:63]
    v_perm_b32 v220, v117, v113, s62
    v_mfma_f32_16x16x32_bf16 v[64:67], v[224:227], v[20:23], v[64:67]
    v_perm_b32 v224, v118, v114, s61
    v_mfma_f32_16x16x32_bf16 v[68:71], v[228:231], v[20:23], v[68:71]
    v_perm_b32 v228, v118, v114, s62
    v_mfma_f32_16x16x32_bf16 v[72:75], v[232:235], v[20:23], v[72:75]
    v_perm_b32 v232, v119, v115, s61
    v_mfma_f32_16x16x32_bf16 v[76:79], v[236:239], v[20:23], v[76:79]
    v_perm_b32 v236, v119, v115, s62
    s_waitcnt vmcnt(20)
    ds_read_b128 v[20:23], v17 offset:22528
    v_perm_b32 v209, v124, v120, s61
    v_perm_b32 v213, v124, v120, s62
    v_perm_b32 v217, v125, v121, s61
    v_perm_b32 v221, v125, v121, s62
    v_perm_b32 v225, v126, v122, s61
    v_perm_b32 v229, v126, v122, s62
    v_perm_b32 v233, v127, v123, s61
    v_perm_b32 v237, v127, v123, s62
    s_waitcnt vmcnt(18)
    v_perm_b32 v210, v132, v128, s61
    v_perm_b32 v214, v132, v128, s62
    v_perm_b32 v218, v133, v129, s61
    v_perm_b32 v222, v133, v129, s62
    v_perm_b32 v226, v134, v130, s61
    v_perm_b32 v230, v134, v130, s62
    v_perm_b32 v234, v135, v131, s61
    v_perm_b32 v238, v135, v131, s62
    s_waitcnt vmcnt(16)
    v_perm_b32 v211, v140, v136, s61
    v_perm_b32 v215, v140, v136, s62
    v_perm_b32 v219, v141, v137, s61
    v_perm_b32 v223, v141, v137, s62
    v_perm_b32 v227, v142, v138, s61
    v_perm_b32 v231, v142, v138, s62
    v_perm_b32 v235, v143, v139, s61
    v_perm_b32 v239, v143, v139, s62
    s_waitcnt vmcnt(14)
    s_waitcnt lgkmcnt(1)
    v_mfma_f32_16x16x32_bf16 v[48:51], v[208:211], v[24:27], v[48:51]
    v_perm_b32 v208, v148, v144, s61
    v_mfma_f32_16x16x32_bf16 v[52:55], v[212:215], v[24:27], v[52:55]
    v_perm_b32 v212, v148, v144, s62
    v_mfma_f32_16x16x32_bf16 v[56:59], v[216:219], v[24:27], v[56:59]
    v_perm_b32 v216, v149, v145, s61
    v_mfma_f32_16x16x32_bf16 v[60:63], v[220:223], v[24:27], v[60:63]
    v_perm_b32 v220, v149, v145, s62
    v_mfma_f32_16x16x32_bf16 v[64:67], v[224:227], v[24:27], v[64:67]
    v_perm_b32 v224, v150, v146, s61
    v_mfma_f32_16x16x32_bf16 v[68:71], v[228:231], v[24:27], v[68:71]
    v_perm_b32 v228, v150, v146, s62
    v_mfma_f32_16x16x32_bf16 v[72:75], v[232:235], v[24:27], v[72:75]
    v_perm_b32 v232, v151, v147, s61
    v_mfma_f32_16x16x32_bf16 v[76:79], v[236:239], v[24:27], v[76:79]
    v_perm_b32 v236, v151, v147, s62
    s_waitcnt vmcnt(12)
    ds_read_b128 v[24:27], v17 offset:23552
    v_perm_b32 v209, v156, v152, s61
    v_perm_b32 v213, v156, v152, s62
    v_perm_b32 v217, v157, v153, s61
    v_perm_b32 v221, v157, v153, s62
    v_perm_b32 v225, v158, v154, s61
    v_perm_b32 v229, v158, v154, s62
    v_perm_b32 v233, v159, v155, s61
    v_perm_b32 v237, v159, v155, s62
    s_waitcnt vmcnt(10)
    v_perm_b32 v210, v164, v160, s61
    v_perm_b32 v214, v164, v160, s62
    v_perm_b32 v218, v165, v161, s61
    v_perm_b32 v222, v165, v161, s62
    v_perm_b32 v226, v166, v162, s61
    v_perm_b32 v230, v166, v162, s62
    v_perm_b32 v234, v167, v163, s61
    v_perm_b32 v238, v167, v163, s62
    s_waitcnt vmcnt(8)
    v_perm_b32 v211, v172, v168, s61
    v_perm_b32 v215, v172, v168, s62
    v_perm_b32 v219, v173, v169, s61
    v_perm_b32 v223, v173, v169, s62
    v_perm_b32 v227, v174, v170, s61
    v_perm_b32 v231, v174, v170, s62
    v_perm_b32 v235, v175, v171, s61
    v_perm_b32 v239, v175, v171, s62
    s_waitcnt vmcnt(6)
    s_waitcnt lgkmcnt(1)
    v_mfma_f32_16x16x32_bf16 v[48:51], v[208:211], v[20:23], v[48:51]
    v_perm_b32 v208, v180, v176, s61
    v_mfma_f32_16x16x32_bf16 v[52:55], v[212:215], v[20:23], v[52:55]
    v_perm_b32 v212, v180, v176, s62
    v_mfma_f32_16x16x32_bf16 v[56:59], v[216:219], v[20:23], v[56:59]
    v_perm_b32 v216, v181, v177, s61
    v_mfma_f32_16x16x32_bf16 v[60:63], v[220:223], v[20:23], v[60:63]
    v_perm_b32 v220, v181, v177, s62
    v_mfma_f32_16x16x32_bf16 v[64:67], v[224:227], v[20:23], v[64:67]
    v_perm_b32 v224, v182, v178, s61
    v_mfma_f32_16x16x32_bf16 v[68:71], v[228:231], v[20:23], v[68:71]
    v_perm_b32 v228, v182, v178, s62
    v_mfma_f32_16x16x32_bf16 v[72:75], v[232:235], v[20:23], v[72:75]
    v_perm_b32 v232, v183, v179, s61
    v_mfma_f32_16x16x32_bf16 v[76:79], v[236:239], v[20:23], v[76:79]
    v_perm_b32 v236, v183, v179, s62
    s_waitcnt vmcnt(4)
    v_perm_b32 v209, v188, v184, s61
    v_perm_b32 v213, v188, v184, s62
    v_perm_b32 v217, v189, v185, s61
    v_perm_b32 v221, v189, v185, s62
    v_perm_b32 v225, v190, v186, s61
    v_perm_b32 v229, v190, v186, s62
    v_perm_b32 v233, v191, v187, s61
    v_perm_b32 v237, v191, v187, s62
    s_waitcnt vmcnt(2)
    v_perm_b32 v210, v196, v192, s61
    v_perm_b32 v214, v196, v192, s62
    v_perm_b32 v218, v197, v193, s61
    v_perm_b32 v222, v197, v193, s62
    v_perm_b32 v226, v198, v194, s61
    v_perm_b32 v230, v198, v194, s62
    v_perm_b32 v234, v199, v195, s61
    v_perm_b32 v238, v199, v195, s62
    s_cmp_gt_u32 s55, 24
    s_cbranch_scc1 L_vmore
    s_bitcmp1_b32 s41, 0
    s_cbranch_scc1 L_slowo
    s_waitcnt vmcnt(0) lgkmcnt(0)
    v_perm_b32 v211, v204, v200, s61
    v_perm_b32 v215, v204, v200, s62
    v_perm_b32 v219, v205, v201, s61
    v_perm_b32 v223, v205, v201, s62
    v_mfma_f32_16x16x32_bf16 v[48:51], v[208:211], v[24:27], v[48:51]
    v_mfma_f32_16x16x32_bf16 v[52:55], v[212:215], v[24:27], v[52:55]
    v_perm_b32 v227, v206, v202, s61
    v_perm_b32 v231, v206, v202, s62
    v_mfma_f32_16x16x32_bf16 v[56:59], v[216:219], v[24:27], v[56:59]
    v_mfma_f32_16x16x32_bf16 v[60:63], v[220:223], v[24:27], v[60:63]
    v_perm_b32 v235, v207, v203, s61
    v_perm_b32 v239, v207, v203, s62
    v_mfma_f32_16x16x32_bf16 v[64:67], v[224:227], v[24:27], v[64:67]
    v_mfma_f32_16x16x32_bf16 v[68:71], v[228:231], v[24:27], v[68:71]
    v_perm_b32 v48, v48, v18, s39
    v_perm_b32 v51, v51, v18, s40
    buffer_store_dwordx4 v[48:51], v42, s[32:35], 0 offen
    v_mfma_f32_16x16x32_bf16 v[72:75], v[232:235], v[24:27], v[72:75]
    v_mfma_f32_16x16x32_bf16 v[76:79], v[236:239], v[24:27], v[76:79]
    v_perm_b32 v52, v52, v18, s39
    v_perm_b32 v55, v55, v18, s40
    buffer_store_dwordx4 v[52:55], v42, s[32:35], s65 offen
    v_perm_b32 v56, v56, v18, s39
    v_perm_b32 v59, v59, v18, s40
    buffer_store_dwordx4 v[56:59], v42, s[32:35], s66 offen
    v_perm_b32 v60, v60, v18, s39
    v_perm_b32 v63, v63, v18, s40
    buffer_store_dwordx4 v[60:63], v42, s[32:35], s67 offen
    v_perm_b32 v64, v64, v18, s39
    v_perm_b32 v67, v67, v18, s40
    buffer_store_dwordx4 v[64:67], v42, s[32:35], s68 offen
    v_perm_b32 v68, v68, v18, s39
    v_perm_b32 v71, v71, v18, s40
    buffer_store_dwordx4 v[68:71], v42, s[32:35], s69 offen
    v_perm_b32 v72, v72, v18, s39
    v_perm_b32 v75, v75, v18, s40
    buffer_store_dwordx4 v[72:75], v42, s[32:35], s70 offen
    v_perm_b32 v76, v76, v18, s39
    v_perm_b32 v79, v79, v18, s40
    buffer_store_dwordx4 v[76:79], v42, s[32:35], s71 offen
    s_endpgm
L_cmain:
    s_barrier
    s_lshr_b32 s50, s50, 6
    s_and_b32 s51, s50, 3
    v_mov_b32 v15, 0
    v_lshrrev_b32 v12, 2, v1
    v_and_b32 v50, 0xff, v12
    v_add_u32 v50, 2048, v50
    v_and_b32 v12, 0x1fc, v12
    s_lshr_b32 s92, s51, 1
    s_lshl_b32 s92, s92, 2
    v_mov_b32 v11, s92
    s_waitcnt lgkmcnt(0)
    s_min_i32 s92, s36, 0x2000
    s_cmp_lt_i32 s36, 1
    s_cselect_b32 s36, 0x2000, s92
    s_cselect_b32 s92, 0xf000f, 0
    s_mov_b32 s88, s92
    s_min_i32 s92, s37, 0x2000
    s_cmp_lt_i32 s37, 1
    s_cselect_b32 s37, 0x2000, s92
    s_cselect_b32 s92, 0xf000f0, 0
    s_or_b32 s88, s88, s92
    s_min_i32 s92, s38, 0x2000
    s_cmp_lt_i32 s38, 1
    s_cselect_b32 s38, 0x2000, s92
    s_cselect_b32 s92, 0xf000f00, 0
    s_or_b32 s88, s88, s92
    s_min_i32 s92, s39, 0x2000
    s_cmp_lt_i32 s39, 1
    s_cselect_b32 s39, 0x2000, s92
    s_cselect_b32 s92, 0xf000f000, 0
    s_or_b32 s88, s88, s92
    s_cmp_lt_u32 s51, 2
    s_cselect_b32 s92, s36, s37
    s_lshr_b32 s93, s92, 4
    v_sub_u32 v8, s93, v12
    s_and_b32 s92, s92, 15
    s_cselect_b32 s92, 0x10000, 0
    v_mov_b32 v9, s92
    v_cmp_eq_i32 s[72:73], 0, v8
    v_cmp_eq_i32 s[74:75], 1, v8
    v_cmp_eq_i32 s[76:77], 2, v8
    v_cmp_eq_i32 s[78:79], 3, v8
    v_cmp_lt_i32 s[64:65], 0, v8
    v_cmp_lt_i32 s[66:67], 1, v8
    v_cmp_lt_i32 s[68:69], 2, v8
    v_cmp_lt_i32 s[70:71], 3, v8
    v_cndmask_b32 v84, 0, v9, s[72:73]
    v_cndmask_b32 v85, 0, v9, s[74:75]
    v_cndmask_b32 v86, 0, v9, s[76:77]
    v_cndmask_b32 v87, 0, v9, s[78:79]
    v_cndmask_b32 v84, v84, 1, s[64:65]
    v_cndmask_b32 v85, v85, 1, s[66:67]
    v_cndmask_b32 v86, v86, 1, s[68:69]
    v_cndmask_b32 v87, v87, 1, s[70:71]
    s_cmp_lt_u32 s51, 2
    s_cselect_b32 s92, s38, s39
    s_lshr_b32 s93, s92, 4
    v_sub_u32 v8, s93, v12
    s_and_b32 s92, s92, 15
    s_cselect_b32 s92, 0x10000, 0
    v_mov_b32 v9, s92
    v_cmp_eq_i32 s[72:73], 0, v8
    v_cmp_eq_i32 s[74:75], 1, v8
    v_cmp_eq_i32 s[76:77], 2, v8
    v_cmp_eq_i32 s[78:79], 3, v8
    v_cmp_lt_i32 s[64:65], 0, v8
    v_cmp_lt_i32 s[66:67], 1, v8
    v_cmp_lt_i32 s[68:69], 2, v8
    v_cmp_lt_i32 s[70:71], 3, v8
    v_cndmask_b32 v88, 0, v9, s[72:73]
    v_cndmask_b32 v89, 0, v9, s[74:75]
    v_cndmask_b32 v90, 0, v9, s[76:77]
    v_cndmask_b32 v91, 0, v9, s[78:79]
    v_cndmask_b32 v88, v88, 1, s[64:65]
    v_cndmask_b32 v89, v89, 1, s[66:67]
    v_cndmask_b32 v90, v90, 1, s[68:69]
    v_cndmask_b32 v91, v91, 1, s[70:71]
    s_movk_i32 s94, 0x3f0
    s_waitcnt vmcnt(1)
    v_lshrrev_b32 v8, 8, v76
    v_lshl_add_u32 v8, v8, 3, v76
    v_lshrrev_b32 v76, 1, v76
    v_and_b32 v8, 31, v8
    v_and_or_b32 v76, v76, s94, v11
    v_cmpx_eq_u32 vcc, s49, v8
    ds_add_u32 v76, v84 offset:1024
    s_mov_b64 exec, -1
    v_lshrrev_b32 v9, 8, v77
    v_lshl_add_u32 v9, v9, 3, v77
    v_lshrrev_b32 v77, 1, v77
    v_and_b32 v9, 31, v9
    v_and_or_b32 v77, v77, s94, v11
    v_cmpx_eq_u32 vcc, s49, v9
    ds_add_u32 v77, v85 offset:1024
    s_mov_b64 exec, -1
    v_lshrrev_b32 v8, 8, v78
    v_lshl_add_u32 v8, v8, 3, v78
    v_lshrrev_b32 v78, 1, v78
    v_and_b32 v8, 31, v8
    v_and_or_b32 v78, v78, s94, v11
    v_cmpx_eq_u32 vcc, s49, v8
    ds_add_u32 v78, v86 offset:1024
    s_mov_b64 exec, -1
    v_lshrrev_b32 v9, 8, v79
    v_lshl_add_u32 v9, v9, 3, v79
    v_lshrrev_b32 v79, 1, v79
    v_and_b32 v9, 31, v9
    v_and_or_b32 v79, v79, s94, v11
    v_cmpx_eq_u32 vcc, s49, v9
    ds_add_u32 v79, v87 offset:1024
    s_mov_b64 exec, -1
    s_waitcnt vmcnt(0)
    v_lshrrev_b32 v8, 8, v80
    v_lshl_add_u32 v8, v8, 3, v80
    v_lshrrev_b32 v80, 1, v80
    v_and_b32 v8, 31, v8
    v_and_or_b32 v80, v80, s94, v11
    v_cmpx_eq_u32 vcc, s49, v8
    ds_add_u32 v80, v88 offset:1032
    s_mov_b64 exec, -1
    v_lshrrev_b32 v9, 8, v81
    v_lshl_add_u32 v9, v9, 3, v81
    v_lshrrev_b32 v81, 1, v81
    v_and_b32 v9, 31, v9
    v_and_or_b32 v81, v81, s94, v11
    v_cmpx_eq_u32 vcc, s49, v9
    ds_add_u32 v81, v89 offset:1032
    s_mov_b64 exec, -1
    v_lshrrev_b32 v8, 8, v82
    v_lshl_add_u32 v8, v8, 3, v82
    v_lshrrev_b32 v82, 1, v82
    v_and_b32 v8, 31, v8
    v_and_or_b32 v82, v82, s94, v11
    v_cmpx_eq_u32 vcc, s49, v8
    ds_add_u32 v82, v90 offset:1032
    s_mov_b64 exec, -1
    v_lshrrev_b32 v9, 8, v83
    v_lshl_add_u32 v9, v9, 3, v83
    v_lshrrev_b32 v83, 1, v83
    v_and_b32 v9, 31, v9
    v_and_or_b32 v83, v83, s94, v11
    v_cmpx_eq_u32 vcc, s49, v9
    ds_add_u32 v83, v91 offset:1032
    s_mov_b64 exec, -1
    v_mov_b32 v8, 1
    s_mov_b64 exec, 1
    ds_add_u32 v15, v8 offset:3088
    s_mov_b64 exec, -1
    s_mov_b32 s28, s4
    s_mov_b32 s29, s5
    s_mov_b32 s30, 32768
    s_mov_b32 s31, 0x20000
    s_lshl_b32 s93, s51, 6
    v_xor_b32 v10, s93, v14
    v_lshl_add_u32 v10, v2, 8, v10
    s_lshl_b32 s93, s48, 10
    s_lshl_b32 s94, s51, 13
    s_add_u32 s93, s93, s94
    s_lshl_b32 s94, s51, 10
    s_add_u32 m0, s94, 4096
    s_lshl_b32 s92, s48, 7
    s_add_u32 s92, s92, 2195456
    s_load_dword s57, s[18:19], s92
    s_mov_b32 s32, s18
    s_mov_b32 s33, s19
    s_mov_b32 s34, 268435456
    s_mov_b32 s35, 0x20000
    v_mov_b32 v15, 0
    v_and_b32 v17, 0x3f0, v1
    s_mov_b32 s63, 4
    buffer_load_dwordx4 v10, s[28:31], s93 offen lds
    v_lshrrev_b32 v51, 4, v17
    s_lshl_b32 s52, s51, 12
    s_addk_i32 s52, 8192
    s_lshr_b32 s92, s51, 1
    s_lshl_b32 s92, s92, 10
    s_and_b32 s93, s51, 1
    s_lshl_b32 s93, s93, 3
    s_add_u32 s92, s92, s93
    v_add_u32 v16, s92, v17
    v_lshlrev_b32 v8, 8, v3
    v_add_u32 v8, s52, v8
    v_add_u32 v40, v14, v8
    v_xor_b32 v41, 64, v40
    v_xor_b32 v42, 128, v40
    v_xor_b32 v43, 192, v40
    v_and_b32 v47, 12, v3
    v_mov_b32 v44, 0xf149f2ca
    v_mov_b32 v45, 0
    v_lshlrev_b32 v48, 4, v3
    s_lshl_b32 s92, s51, 2
    v_add_u32 v49, s92, v48
    s_mov_b32 s89, s88
    v_mov_b32 v46, 0x3e0293ee
    v_cndmask_b32 v46, v46, 0, s[88:89]
    s_and_b32 s92, s36, 15
    s_and_b32 s93, s37, 15
    s_lshl_b32 s93, s93, 4
    s_or_b32 s92, s92, s93
    s_and_b32 s93, s38, 15
    s_lshl_b32 s93, s93, 8
    s_or_b32 s92, s92, s93
    s_and_b32 s93, s39, 15
    s_lshl_b32 s93, s93, 12
    s_or_b32 s92, s92, s93
    v_lshrrev_b32 v8, v47, s92
    v_and_b32 v8, 15, v8
    v_lshlrev_b32 v9, 2, v2
    v_sub_u32 v8, v8, v9
    v_cmp_lt_i32 s[64:65], 0, v8
    v_cmp_lt_i32 s[66:67], 1, v8
    v_cmp_lt_i32 s[68:69], 2, v8
    v_cmp_lt_i32 s[70:71], 3, v8
    v_and_b32 v144, 0x1f0, v17
    s_add_u32 s97, s51, 1
    ds_read_b32 v24, v15 offset:3088
    ds_read_b128 v[20:23], v17 offset:1024
    s_waitcnt lgkmcnt(0)
    v_cmp_gt_u32 vcc, 4, v24
    s_cbranch_vccz L_cl_ok
L_cl_again:
    ds_read_b32 v24, v15 offset:3088
    ds_read_b128 v[20:23], v17 offset:1024
    s_waitcnt lgkmcnt(0)
    v_cmp_gt_u32 vcc, 4, v24
    s_cbranch_vccnz L_cl_again
L_cl_ok:
    v_or3_b32 v20, v20, v21, v22
    v_or_b32 v20, v20, v23
    v_cmp_ne_u32 vcc, 0, v20
    s_nop 0
    s_lshr_b64 s[72:73], vcc, 8
    s_bcnt1_i32_b32 s55, s72
    v_mbcnt_lo_u32_b32 v8, s72, 0
    s_lshr_b32 s56, vcc_lo, s51
    v_and_b32 v8, 3, v8
    v_cmp_eq_u32 vcc, s51, v8
    s_andn2_b32 s56, 0x11, s56
    s_and_b32 s53, vcc_lo, s72
    s_waitcnt vmcnt(0)
    v_mov_b32 v8, 1
    s_mov_b64 exec, 1
    ds_add_u32 v15, v8 offset:3092
    s_mov_b64 exec, -1
    s_add_u32 s57, s57, 1
    s_not_b32 s58, s57
    s_getreg_b32 s59, hwreg(HW_REG_XCC_ID, 0, 4)
    s_lshl_b32 s60, s48, 9
    s_add_u32 s60, s60, 2162688
    s_cmp_lg_u32 s50, 4
    s_cbranch_scc1 L_noarr
    s_lshl_b32 s92, s49, 4
    v_mov_b32 v4, s92
    v_mov_b32 v92, s57
    v_mov_b32 v93, s58
    v_mov_b32 v94, s59
    s_mov_b64 exec, 1
    buffer_store_dwordx3 v[92:94], v4, s[32:35], s60 offen sc1
    s_mov_b64 exec, -1
L_noarr:
L_sq:
    ds_read_b32 v8, v15 offset:3092
    s_waitcnt lgkmcnt(0)
    v_cmp_gt_u32 vcc, 4, v8
    s_cbranch_vccnz L_sq
    s_lshl_b32 s96, s51, 4
    v_add_u32 v52, s96, v47
    ds_read_b32 v53, v52 offset:1088
    ds_read_b32 v52, v52 offset:1024
    s_sub_u32 s92, s52, 4096
    v_subrev_u32 v4, s92, v40
    ds_read_b128 v[60:63], v4
    v_subrev_u32 v5, s92, v41
    ds_read_b128 v[64:67], v5
    v_subrev_u32 v6, s92, v42
    ds_read_b128 v[68:71], v6
    v_subrev_u32 v7, s92, v43
    ds_read_b128 v[72:75], v7
L_kround:
    s_ff1_i32_b32 s92, s53
    s_bitset0_b32 s53, s92
    s_lshl_b32 s96, s92, 4
    s_addk_i32 s96, 128
    s_cmp_lt_i32 s92, 0
    s_cselect_b32 s96, 2112, s96
    v_add_u32 v54, s96, v47
    ds_read_b32 v54, v54 offset:1024
    s_ff1_i32_b32 s92, s53
    s_bitset0_b32 s53, s92
    s_lshl_b32 s96, s92, 4
    s_addk_i32 s96, 128
    s_cmp_lt_i32 s92, 0
    s_cselect_b32 s96, 2112, s96
    v_add_u32 v55, s96, v47
    ds_read_b32 v55, v55 offset:1024
    s_ff1_i32_b32 s92, s53
    s_bitset0_b32 s53, s92
    s_lshl_b32 s96, s92, 4
    s_addk_i32 s96, 128
    s_cmp_lt_i32 s92, 0
    s_cselect_b32 s96, 2112, s96
    v_add_u32 v56, s96, v47
    ds_read_b32 v56, v56 offset:1024
    s_ff1_i32_b32 s92, s53
    s_bitset0_b32 s53, s92
    s_lshl_b32 s96, s92, 4
    s_addk_i32 s96, 128
    s_cmp_lt_i32 s92, 0
    s_cselect_b32 s96, 2112, s96
    v_add_u32 v57, s96, v47
    ds_read_b32 v57, v57 offset:1024
    s_ff1_i32_b32 s92, s53
    s_bitset0_b32 s53, s92
    s_lshl_b32 s96, s92, 4
    s_addk_i32 s96, 128
    s_cmp_lt_i32 s92, 0
    s_cselect_b32 s96, 2112, s96
    v_add_u32 v58, s96, v47
    ds_read_b32 v58, v58 offset:1024
    s_ff1_i32_b32 s92, s53
    s_bitset0_b32 s53, s92
    s_lshl_b32 s96, s92, 4
    s_addk_i32 s96, 128
    s_cmp_lt_i32 s92, 0
    s_cselect_b32 s96, 2112, s96
    v_add_u32 v59, s96, v47
    ds_read_b32 v59, v59 offset:1024
L_kw0:
    ds_read_b32 v5, v50
    s_waitcnt lgkmcnt(0)
    v_cmp_gt_u32 vcc, s97, v5
    s_cbranch_vccnz L_kw0
    s_add_u32 s97, s97, 4
    ds_read_b128 v[108:111], v40 offset:0
    ds_read_b128 v[112:115], v41 offset:0
    ds_read_b128 v[116:119], v42 offset:0
    ds_read_b128 v[120:123], v43 offset:0
    s_waitcnt lgkmcnt(3)
    v_mfma_f32_16x16x32_bf16 v[76:79], v[108:111], v[60:63], 0
    s_waitcnt lgkmcnt(2)
    v_mfma_f32_16x16x32_bf16 v[76:79], v[112:115], v[64:67], v[76:79]
    s_waitcnt lgkmcnt(1)
    v_mfma_f32_16x16x32_bf16 v[76:79], v[116:119], v[68:71], v[76:79]
    s_waitcnt lgkmcnt(0)
    v_mfma_f32_16x16x32_bf16 v[76:79], v[120:123], v[72:75], v[76:79]
    s_nop 5
    s_bitcmp1_b32 s56, 0
    s_cbranch_scc0 L_good0
    v_mov_b32 v76, 0
    v_mov_b32 v77, 0
    v_mov_b32 v78, 0
    v_mov_b32 v79, 0
L_good0:
    v_and_b32 v8, 0xffff, v52
    v_lshrrev_b32 v9, 16, v52
    v_add_u32 v9, v9, v8
    v_cvt_f32_u32 v8, v8
    v_cvt_f32_u32 v9, v9
    v_log_f32 v8, v8
    v_log_f32 v9, v9
    s_nop 0
    v_cndmask_b32 v10, v8, v9, s[64:65]
    v_cndmask_b32 v11, v8, v9, s[66:67]
    v_cndmask_b32 v12, v8, v9, s[68:69]
    v_cndmask_b32 v13, v8, v9, s[70:71]
    v_fma_f32 v76, v76, v46, v10
    v_fma_f32 v77, v77, v46, v11
    v_fma_f32 v78, v78, v46, v12
    v_fma_f32 v79, v79, v46, v13
    v_max3_f32 v4, v44, v76, v77
    v_max3_f32 v4, v4, v78, v79
L_kw1:
    ds_read_b32 v5, v50
    s_waitcnt lgkmcnt(0)
    v_cmp_gt_u32 vcc, s97, v5
    s_cbranch_vccnz L_kw1
    s_add_u32 s97, s97, 4
    ds_read_b128 v[124:127], v40 offset:16384
    ds_read_b128 v[128:131], v41 offset:16384
    ds_read_b128 v[132:135], v42 offset:16384
    ds_read_b128 v[136:139], v43 offset:16384
    s_waitcnt lgkmcnt(3)
    v_mfma_f32_16x16x32_bf16 v[80:83], v[124:127], v[60:63], 0
    s_waitcnt lgkmcnt(2)
    v_mfma_f32_16x16x32_bf16 v[80:83], v[128:131], v[64:67], v[80:83]
    s_waitcnt lgkmcnt(1)
    v_mfma_f32_16x16x32_bf16 v[80:83], v[132:135], v[68:71], v[80:83]
    s_waitcnt lgkmcnt(0)
    v_mfma_f32_16x16x32_bf16 v[80:83], v[136:139], v[72:75], v[80:83]
    s_nop 5
    s_bitcmp1_b32 s56, 4
    s_cbranch_scc0 L_good1
    v_mov_b32 v80, 0
    v_mov_b32 v81, 0
    v_mov_b32 v82, 0
    v_mov_b32 v83, 0
L_good1:
    v_and_b32 v8, 0xffff, v53
    v_lshrrev_b32 v9, 16, v53
    v_add_u32 v9, v9, v8
    v_cvt_f32_u32 v8, v8
    v_cvt_f32_u32 v9, v9
    v_log_f32 v8, v8
    v_log_f32 v9, v9
    s_nop 0
    v_cndmask_b32 v10, v8, v9, s[64:65]
    v_cndmask_b32 v11, v8, v9, s[66:67]
    v_cndmask_b32 v12, v8, v9, s[68:69]
    v_cndmask_b32 v13, v8, v9, s[70:71]
    v_fma_f32 v80, v80, v46, v10
    v_fma_f32 v81, v81, v46, v11
    v_fma_f32 v82, v82, v46, v12
    v_fma_f32 v83, v83, v46, v13
    v_max3_f32 v4, v4, v80, v81
    v_max3_f32 v4, v4, v82, v83
L_kw2:
    ds_read_b32 v5, v50
    s_waitcnt lgkmcnt(0)
    v_cmp_gt_u32 vcc, s97, v5
    s_cbranch_vccnz L_kw2
    s_add_u32 s97, s97, 4
    ds_read_b128 v[108:111], v40 offset:32768
    ds_read_b128 v[112:115], v41 offset:32768
    ds_read_b128 v[116:119], v42 offset:32768
    ds_read_b128 v[120:123], v43 offset:32768
    s_waitcnt lgkmcnt(3)
    v_mfma_f32_16x16x32_bf16 v[84:87], v[108:111], v[60:63], 0
    s_waitcnt lgkmcnt(2)
    v_mfma_f32_16x16x32_bf16 v[84:87], v[112:115], v[64:67], v[84:87]
    s_waitcnt lgkmcnt(1)
    v_mfma_f32_16x16x32_bf16 v[84:87], v[116:119], v[68:71], v[84:87]
    s_waitcnt lgkmcnt(0)
    v_mfma_f32_16x16x32_bf16 v[84:87], v[120:123], v[72:75], v[84:87]
    v_and_b32 v8, 0xffff, v54
    v_lshrrev_b32 v9, 16, v54
    v_add_u32 v9, v9, v8
    v_cvt_f32_u32 v8, v8
    v_cvt_f32_u32 v9, v9
    v_log_f32 v8, v8
    v_log_f32 v9, v9
    s_nop 0
    v_cndmask_b32 v10, v8, v9, s[64:65]
    v_cndmask_b32 v11, v8, v9, s[66:67]
    v_cndmask_b32 v12, v8, v9, s[68:69]
    v_cndmask_b32 v13, v8, v9, s[70:71]
    v_fma_f32 v84, v84, v46, v10
    v_fma_f32 v85, v85, v46, v11
    v_fma_f32 v86, v86, v46, v12
    v_fma_f32 v87, v87, v46, v13
    v_max3_f32 v4, v4, v84, v85
    v_max3_f32 v4, v4, v86, v87
L_kw3:
    ds_read_b32 v5, v50
    s_waitcnt lgkmcnt(0)
    v_cmp_gt_u32 vcc, s97, v5
    s_cbranch_vccnz L_kw3
    s_add_u32 s97, s97, 4
    ds_read_b128 v[124:127], v40 offset:49152
    ds_read_b128 v[128:131], v41 offset:49152
    ds_read_b128 v[132:135], v42 offset:49152
    ds_read_b128 v[136:139], v43 offset:49152
    s_waitcnt lgkmcnt(3)
    v_mfma_f32_16x16x32_bf16 v[88:91], v[124:127], v[60:63], 0
    s_waitcnt lgkmcnt(2)
    v_mfma_f32_16x16x32_bf16 v[88:91], v[128:131], v[64:67], v[88:91]
    s_waitcnt lgkmcnt(1)
    v_mfma_f32_16x16x32_bf16 v[88:91], v[132:135], v[68:71], v[88:91]
    s_waitcnt lgkmcnt(0)
    v_mfma_f32_16x16x32_bf16 v[88:91], v[136:139], v[72:75], v[88:91]
    v_and_b32 v8, 0xffff, v55
    v_lshrrev_b32 v9, 16, v55
    v_add_u32 v9, v9, v8
    v_cvt_f32_u32 v8, v8
    v_cvt_f32_u32 v9, v9
    v_log_f32 v8, v8
    v_log_f32 v9, v9
    s_nop 0
    v_cndmask_b32 v10, v8, v9, s[64:65]
    v_cndmask_b32 v11, v8, v9, s[66:67]
    v_cndmask_b32 v12, v8, v9, s[68:69]
    v_cndmask_b32 v13, v8, v9, s[70:71]
    v_fma_f32 v88, v88, v46, v10
    v_fma_f32 v89, v89, v46, v11
    v_fma_f32 v90, v90, v46, v12
    v_fma_f32 v91, v91, v46, v13
    v_max3_f32 v4, v4, v88, v89
    v_max3_f32 v4, v4, v90, v91
    v_mov_b32 v5, v4
    s_nop 1
    v_permlane32_swap_b32 v4, v5
    s_nop 0
    v_max_f32 v4, v4, v5
    v_mov_b32 v5, v4
    s_nop 1
    v_permlane16_swap_b32 v4, v5
    s_nop 0
    v_max_f32 v4, v4, v5
    ds_write_b32 v49, v4
    v_mov_b32 v5, 1
    s_mov_b64 exec, 1
    ds_add_u32 v15, v5 offset:3072
    s_mov_b64 exec, -1
    v_xor_b32 v40, 0x10000, v40
    v_xor_b32 v41, 0x10000, v41
    v_xor_b32 v42, 0x10000, v42
    v_xor_b32 v43, 0x10000, v43
L_s10:
    ds_read_b32 v5, v15 offset:3072
    s_waitcnt lgkmcnt(0)
    v_cmp_gt_u32 vcc, s63, v5
    s_cbranch_vccnz L_s10
    ds_read_b128 v[8:11], v48
    s_waitcnt lgkmcnt(0)
    v_max3_f32 v4, v8, v9, v10
    v_max_f32 v4, v4, v11
    v_sub_f32 v6, v44, v4
    v_exp_f32 v6, v6
    v_mov_b32 v44, v4
    v_pk_add_f32 v[76:77], v[76:77], v[4:5] op_sel_hi:[1,0] neg_lo:[0,1] neg_hi:[0,1]
    v_pk_add_f32 v[78:79], v[78:79], v[4:5] op_sel_hi:[1,0] neg_lo:[0,1] neg_hi:[0,1]
    v_pk_add_f32 v[80:81], v[80:81], v[4:5] op_sel_hi:[1,0] neg_lo:[0,1] neg_hi:[0,1]
    v_pk_add_f32 v[82:83], v[82:83], v[4:5] op_sel_hi:[1,0] neg_lo:[0,1] neg_hi:[0,1]
    v_pk_add_f32 v[84:85], v[84:85], v[4:5] op_sel_hi:[1,0] neg_lo:[0,1] neg_hi:[0,1]
    v_pk_add_f32 v[86:87], v[86:87], v[4:5] op_sel_hi:[1,0] neg_lo:[0,1] neg_hi:[0,1]
    v_pk_add_f32 v[88:89], v[88:89], v[4:5] op_sel_hi:[1,0] neg_lo:[0,1] neg_hi:[0,1]
    v_pk_add_f32 v[90:91], v[90:91], v[4:5] op_sel_hi:[1,0] neg_lo:[0,1] neg_hi:[0,1]
    v_mul_f32 v45, v45, v6
    ds_write_b32 v50, v6 offset:256
    v_exp_f32 v76, v76
    v_exp_f32 v77, v77
    v_exp_f32 v78, v78
    v_exp_f32 v79, v79
    v_exp_f32 v80, v80
    v_exp_f32 v81, v81
    v_exp_f32 v82, v82
    v_exp_f32 v83, v83
    v_exp_f32 v84, v84
    v_exp_f32 v85, v85
    v_exp_f32 v86, v86
    v_exp_f32 v87, v87
    v_exp_f32 v88, v88
    v_exp_f32 v89, v89
    v_exp_f32 v90, v90
    v_exp_f32 v91, v91
    v_cvt_pk_bf16_f32 v20, v76, v77
    v_cvt_pk_bf16_f32 v21, v78, v79
    v_cvt_pk_bf16_f32 v22, v80, v81
    v_cvt_pk_bf16_f32 v23, v82, v83
    v_cvt_pk_bf16_f32 v24, v84, v85
    v_cvt_pk_bf16_f32 v25, v86, v87
    v_cvt_pk_bf16_f32 v26, v88, v89
    v_cvt_pk_bf16_f32 v27, v90, v91
    ds_write_b64 v16, v[20:21] offset:8192
    ds_write_b64 v16, v[22:23] offset:10240
    ds_write_b64 v16, v[24:25] offset:12288
    ds_write_b64 v16, v[26:27] offset:14336
    v_pk_add_f32 v[76:77], v[76:77], v[84:85]
    v_pk_add_f32 v[78:79], v[78:79], v[86:87]
    v_pk_add_f32 v[80:81], v[80:81], v[88:89]
    v_pk_add_f32 v[82:83], v[82:83], v[90:91]
    v_pk_add_f32 v[76:77], v[76:77], v[80:81]
    v_pk_add_f32 v[78:79], v[78:79], v[82:83]
    v_pk_add_f32 v[76:77], v[76:77], v[78:79]
    v_add_f32 v76, v76, v77
    v_add_f32 v45, v45, v76
    v_mov_b32 v5, 1
    s_mov_b64 exec, 1
    ds_add_u32 v15, v5 offset:3076
    s_mov_b64 exec, -1
L_s20:
    ds_read_b32 v5, v15 offset:3076
    s_waitcnt lgkmcnt(0)
    v_cmp_gt_u32 vcc, s63, v5
    s_cbranch_vccnz L_s20
    s_add_u32 s63, s63, 4
L_kw4:
    ds_read_b32 v5, v50
    s_waitcnt lgkmcnt(0)
    v_cmp_gt_u32 vcc, s97, v5
    s_cbranch_vccnz L_kw4
    s_add_u32 s97, s97, 4
    ds_read_b128 v[108:111], v40 offset:0
    ds_read_b128 v[112:115], v41 offset:0
    ds_read_b128 v[116:119], v42 offset:0
    ds_read_b128 v[120:123], v43 offset:0
    s_waitcnt lgkmcnt(3)
    v_mfma_f32_16x16x32_bf16 v[76:79], v[108:111], v[60:63], 0
    s_waitcnt lgkmcnt(2)
    v_mfma_f32_16x16x32_bf16 v[76:79], v[112:115], v[64:67], v[76:79]
    s_waitcnt lgkmcnt(1)
    v_mfma_f32_16x16x32_bf16 v[76:79], v[116:119], v[68:71], v[76:79]
    s_waitcnt lgkmcnt(0)
    v_mfma_f32_16x16x32_bf16 v[76:79], v[120:123], v[72:75], v[76:79]
    v_and_b32 v8, 0xffff, v56
    v_lshrrev_b32 v9, 16, v56
    v_add_u32 v9, v9, v8
    v_cvt_f32_u32 v8, v8
    v_cvt_f32_u32 v9, v9
    v_log_f32 v8, v8
    v_log_f32 v9, v9
    s_nop 0
    v_cndmask_b32 v10, v8, v9, s[64:65]
    v_cndmask_b32 v11, v8, v9, s[66:67]
    v_cndmask_b32 v12, v8, v9, s[68:69]
    v_cndmask_b32 v13, v8, v9, s[70:71]
    v_fma_f32 v76, v76, v46, v10
    v_fma_f32 v77, v77, v46, v11
    v_fma_f32 v78, v78, v46, v12
    v_fma_f32 v79, v79, v46, v13
    v_max3_f32 v4, v44, v76, v77
    v_max3_f32 v4, v4, v78, v79
L_kw5:
    ds_read_b32 v5, v50
    s_waitcnt lgkmcnt(0)
    v_cmp_gt_u32 vcc, s97, v5
    s_cbranch_vccnz L_kw5
    s_add_u32 s97, s97, 4
    ds_read_b128 v[124:127], v40 offset:16384
    ds_read_b128 v[128:131], v41 offset:16384
    ds_read_b128 v[132:135], v42 offset:16384
    ds_read_b128 v[136:139], v43 offset:16384
    s_waitcnt lgkmcnt(3)
    v_mfma_f32_16x16x32_bf16 v[80:83], v[124:127], v[60:63], 0
    s_waitcnt lgkmcnt(2)
    v_mfma_f32_16x16x32_bf16 v[80:83], v[128:131], v[64:67], v[80:83]
    s_waitcnt lgkmcnt(1)
    v_mfma_f32_16x16x32_bf16 v[80:83], v[132:135], v[68:71], v[80:83]
    s_waitcnt lgkmcnt(0)
    v_mfma_f32_16x16x32_bf16 v[80:83], v[136:139], v[72:75], v[80:83]
    v_and_b32 v8, 0xffff, v57
    v_lshrrev_b32 v9, 16, v57
    v_add_u32 v9, v9, v8
    v_cvt_f32_u32 v8, v8
    v_cvt_f32_u32 v9, v9
    v_log_f32 v8, v8
    v_log_f32 v9, v9
    s_nop 0
    v_cndmask_b32 v10, v8, v9, s[64:65]
    v_cndmask_b32 v11, v8, v9, s[66:67]
    v_cndmask_b32 v12, v8, v9, s[68:69]
    v_cndmask_b32 v13, v8, v9, s[70:71]
    v_fma_f32 v80, v80, v46, v10
    v_fma_f32 v81, v81, v46, v11
    v_fma_f32 v82, v82, v46, v12
    v_fma_f32 v83, v83, v46, v13
    v_max3_f32 v4, v4, v80, v81
    v_max3_f32 v4, v4, v82, v83
    s_cmp_lg_u32 s50, 4
    s_cbranch_scc1 L_nochk
    s_waitcnt vmcnt(0)
    buffer_load_dwordx3 v[156:158], v144, s[32:35], s60 offen sc1
L_nochk:
L_kw6:
    ds_read_b32 v5, v50
    s_waitcnt lgkmcnt(0)
    v_cmp_gt_u32 vcc, s97, v5
    s_cbranch_vccnz L_kw6
    s_add_u32 s97, s97, 4
    ds_read_b128 v[108:111], v40 offset:32768
    ds_read_b128 v[112:115], v41 offset:32768
    ds_read_b128 v[116:119], v42 offset:32768
    ds_read_b128 v[120:123], v43 offset:32768
    s_waitcnt lgkmcnt(3)
    v_mfma_f32_16x16x32_bf16 v[84:87], v[108:111], v[60:63], 0
    s_waitcnt lgkmcnt(2)
    v_mfma_f32_16x16x32_bf16 v[84:87], v[112:115], v[64:67], v[84:87]
    s_waitcnt lgkmcnt(1)
    v_mfma_f32_16x16x32_bf16 v[84:87], v[116:119], v[68:71], v[84:87]
    s_waitcnt lgkmcnt(0)
    v_mfma_f32_16x16x32_bf16 v[84:87], v[120:123], v[72:75], v[84:87]
    v_and_b32 v8, 0xffff, v58
    v_lshrrev_b32 v9, 16, v58
    v_add_u32 v9, v9, v8
    v_cvt_f32_u32 v8, v8
    v_cvt_f32_u32 v9, v9
    v_log_f32 v8, v8
    v_log_f32 v9, v9
    s_nop 0
    v_cndmask_b32 v10, v8, v9, s[64:65]
    v_cndmask_b32 v11, v8, v9, s[66:67]
    v_cndmask_b32 v12, v8, v9, s[68:69]
    v_cndmask_b32 v13, v8, v9, s[70:71]
    v_fma_f32 v84, v84, v46, v10
    v_fma_f32 v85, v85, v46, v11
    v_fma_f32 v86, v86, v46, v12
    v_fma_f32 v87, v87, v46, v13
    v_max3_f32 v4, v4, v84, v85
    v_max3_f32 v4, v4, v86, v87
L_kw7:
    ds_read_b32 v5, v50
    s_waitcnt lgkmcnt(0)
    v_cmp_gt_u32 vcc, s97, v5
    s_cbranch_vccnz L_kw7
    s_add_u32 s97, s97, 4
    ds_read_b128 v[124:127], v40 offset:49152
    ds_read_b128 v[128:131], v41 offset:49152
    ds_read_b128 v[132:135], v42 offset:49152
    ds_read_b128 v[136:139], v43 offset:49152
    s_waitcnt lgkmcnt(3)
    v_mfma_f32_16x16x32_bf16 v[88:91], v[124:127], v[60:63], 0
    s_waitcnt lgkmcnt(2)
    v_mfma_f32_16x16x32_bf16 v[88:91], v[128:131], v[64:67], v[88:91]
    s_waitcnt lgkmcnt(1)
    v_mfma_f32_16x16x32_bf16 v[88:91], v[132:135], v[68:71], v[88:91]
    s_waitcnt lgkmcnt(0)
    v_mfma_f32_16x16x32_bf16 v[88:91], v[136:139], v[72:75], v[88:91]
    v_and_b32 v8, 0xffff, v59
    v_lshrrev_b32 v9, 16, v59
    v_add_u32 v9, v9, v8
    v_cvt_f32_u32 v8, v8
    v_cvt_f32_u32 v9, v9
    v_log_f32 v8, v8
    v_log_f32 v9, v9
    s_nop 0
    v_cndmask_b32 v10, v8, v9, s[64:65]
    v_cndmask_b32 v11, v8, v9, s[66:67]
    v_cndmask_b32 v12, v8, v9, s[68:69]
    v_cndmask_b32 v13, v8, v9, s[70:71]
    v_fma_f32 v88, v88, v46, v10
    v_fma_f32 v89, v89, v46, v11
    v_fma_f32 v90, v90, v46, v12
    v_fma_f32 v91, v91, v46, v13
    v_max3_f32 v4, v4, v88, v89
    v_max3_f32 v4, v4, v90, v91
    v_mov_b32 v5, v4
    s_nop 1
    v_permlane32_swap_b32 v4, v5
    s_nop 0
    v_max_f32 v4, v4, v5
    v_mov_b32 v5, v4
    s_nop 1
    v_permlane16_swap_b32 v4, v5
    s_nop 0
    v_max_f32 v4, v4, v5
    ds_write_b32 v49, v4
    v_mov_b32 v5, 1
    s_mov_b64 exec, 1
    ds_add_u32 v15, v5 offset:3072
    s_mov_b64 exec, -1
    v_xor_b32 v40, 0x10000, v40
    v_xor_b32 v41, 0x10000, v41
    v_xor_b32 v42, 0x10000, v42
    v_xor_b32 v43, 0x10000, v43
    s_cmp_lg_u32 s50, 4
    s_cbranch_scc1 L_decided
    s_lshl_b32 s41, s49, 8
    s_add_u32 s92, s49, 1
    s_lshl_b32 s92, s92, 16
    s_or_b32 s41, s41, s92
    s_mov_b32 s38, 0
L_look:
    s_waitcnt vmcnt(0)
    v_cmp_ne_u32 vcc, s57, v156
    v_cmp_ne_u32 s[72:73], s58, v157
    v_cmp_ne_u32 s[74:75], s59, v158
    v_cmp_le_u32 s[76:77], 64, v158
    s_or_b64 vcc, vcc, s[72:73]
    s_or_b64 s[74:75], s[74:75], vcc
    s_cbranch_scc1 L_notfast
L_modeset:
    v_mov_b32 v5, s41
    ds_write_b32 v15, v5 offset:3104
L_decided:
L_s11:
    ds_read_b32 v5, v15 offset:3072
    s_waitcnt lgkmcnt(0)
    v_cmp_gt_u32 vcc, s63, v5
    s_cbranch_vccnz L_s11
    ds_read_b128 v[8:11], v48
    s_waitcnt lgkmcnt(0)
    v_max3_f32 v4, v8, v9, v10
    v_max_f32 v4, v4, v11
    v_sub_f32 v6, v44, v4
    v_exp_f32 v6, v6
    v_mov_b32 v44, v4
    v_pk_add_f32 v[76:77], v[76:77], v[4:5] op_sel_hi:[1,0] neg_lo:[0,1] neg_hi:[0,1]
    v_pk_add_f32 v[78:79], v[78:79], v[4:5] op_sel_hi:[1,0] neg_lo:[0,1] neg_hi:[0,1]
    v_pk_add_f32 v[80:81], v[80:81], v[4:5] op_sel_hi:[1,0] neg_lo:[0,1] neg_hi:[0,1]
    v_pk_add_f32 v[82:83], v[82:83], v[4:5] op_sel_hi:[1,0] neg_lo:[0,1] neg_hi:[0,1]
    v_pk_add_f32 v[84:85], v[84:85], v[4:5] op_sel_hi:[1,0] neg_lo:[0,1] neg_hi:[0,1]
    v_pk_add_f32 v[86:87], v[86:87], v[4:5] op_sel_hi:[1,0] neg_lo:[0,1] neg_hi:[0,1]
    v_pk_add_f32 v[88:89], v[88:89], v[4:5] op_sel_hi:[1,0] neg_lo:[0,1] neg_hi:[0,1]
    v_pk_add_f32 v[90:91], v[90:91], v[4:5] op_sel_hi:[1,0] neg_lo:[0,1] neg_hi:[0,1]
    v_mul_f32 v45, v45, v6
    ds_write_b32 v50, v6 offset:512
    v_exp_f32 v76, v76
    v_exp_f32 v77, v77
    v_exp_f32 v78, v78
    v_exp_f32 v79, v79
    v_exp_f32 v80, v80
    v_exp_f32 v81, v81
    v_exp_f32 v82, v82
    v_exp_f32 v83, v83
    v_exp_f32 v84, v84
    v_exp_f32 v85, v85
    v_exp_f32 v86, v86
    v_exp_f32 v87, v87
    v_exp_f32 v88, v88
    v_exp_f32 v89, v89
    v_exp_f32 v90, v90
    v_exp_f32 v91, v91
    v_cvt_pk_bf16_f32 v20, v76, v77
    v_cvt_pk_bf16_f32 v21, v78, v79
    v_cvt_pk_bf16_f32 v22, v80, v81
    v_cvt_pk_bf16_f32 v23, v82, v83
    v_cvt_pk_bf16_f32 v24, v84, v85
    v_cvt_pk_bf16_f32 v25, v86, v87
    v_cvt_pk_bf16_f32 v26, v88, v89
    v_cvt_pk_bf16_f32 v27, v90, v91
    ds_write_b64 v16, v[20:21] offset:16384
    ds_write_b64 v16, v[22:23] offset:18432
    ds_write_b64 v16, v[24:25] offset:20480
    ds_write_b64 v16, v[26:27] offset:22528
    v_pk_add_f32 v[76:77], v[76:77], v[84:85]
    v_pk_add_f32 v[78:79], v[78:79], v[86:87]
    v_pk_add_f32 v[80:81], v[80:81], v[88:89]
    v_pk_add_f32 v[82:83], v[82:83], v[90:91]
    v_pk_add_f32 v[76:77], v[76:77], v[80:81]
    v_pk_add_f32 v[78:79], v[78:79], v[82:83]
    v_pk_add_f32 v[76:77], v[76:77], v[78:79]
    v_add_f32 v76, v76, v77
    v_add_f32 v45, v45, v76
    v_mov_b32 v4, v45
    v_mov_b32 v5, v4
    s_nop 1
    v_permlane32_swap_b32 v4, v5
    s_nop 0
    v_add_f32 v4, v4, v5
    v_mov_b32 v5, v4
    s_nop 1
    v_permlane16_swap_b32 v4, v5
    s_nop 0
    v_add_f32 v4, v4, v5
    ds_write_b32 v49, v4 offset:256
    v_mov_b32 v5, 1
    s_mov_b64 exec, 1
    ds_add_u32 v15, v5 offset:3076
    s_mov_b64 exec, -1
L_s21:
    ds_read_b32 v5, v15 offset:3076
    s_waitcnt lgkmcnt(0)
    v_cmp_gt_u32 vcc, s63, v5
    s_cbranch_vccnz L_s21
    s_add_u32 s63, s63, 4
    s_cmp_gt_u32 s55, 24
    s_cbranch_scc1 L_kmore
    s_lshl_b32 s44, s48, 2
    s_add_u32 s44, s44, s51
    s_lshl_b32 s44, s44, 11
    s_add_u32 s44, s44, 2097152
    s_lshl_b32 s92, s49, 6
    s_add_u32 s92, s92, s44
    v_and_b32 v8, 0x30, v17
    v_add_u32 v8, s92, v8
    v_mov_b32 v76, v44
    v_mov_b32 v78, s57
    v_mov_b32 v79, s58
    ds_read_b32 v4, v15 offset:3104
    ds_read_b128 v[80:83], v48 offset:256
    s_waitcnt lgkmcnt(0)
    v_readfirstlane_b32 s41, v4
    v_add_f32 v80, v80, v81
    v_add_f32 v82, v82, v83
    v_add_f32 v77, v80, v82
    s_lshl_b32 s92, s51, 2
    s_lshl_b64 exec, 15, s92
    s_bitcmp1_b32 s41, 0
    s_cbranch_scc1 L_mlslow
    buffer_store_dwordx4 v[76:79], v8, s[32:35], 0 offen
L_mldone:
    s_mov_b64 exec, -1
    v_lshrrev_b32 v4, 2, v51
    v_and_b32 v5, 3, v51
    v_add_u32 v6, s92, v5
    v_lshlrev_b32 v144, 8, v4
    v_lshl_add_u32 v144, v6, 4, v144
    s_lshr_b32 s92, s57, 8
    s_addk_i32 s92, 0x5a
    v_mad_u32_u24 v147, v6, 37, s57
    v_mad_u32_u24 v7, v6, 59, s92
    s_mov_b32 s92, 0x0c0c0400
    v_perm_b32 v147, v7, v147, s92
    s_mov_b32 s40, s92
    s_movk_i32 s39, 0xff00
    s_lshl_b32 s92, s51, 13
    s_lshl_b32 s93, s48, 10
    s_add_u32 s92, s92, s93
    v_lshl_add_u32 v146, v5, 8, s92
    v_and_b32 v4, 1, v2
    v_lshl_add_u32 v146, v4, 5, v146
    v_lshrrev_b32 v4, 1, v2
    v_lshl_add_u32 v146, v4, 4, v146
    v_and_b32 v4, 12, v3
    v_lshl_add_u32 v146, v4, 16, v146
    s_mov_b32 s28, s14
    s_mov_b32 s29, s15
    s_mov_b32 s38, 0
    s_bfe_u32 s36, s41, 0x80008
    s_lshr_b32 s37, s41, 16
    s_cmp_ge_u32 s36, s37
    s_cbranch_scc1 L_fin
    s_getpc_b64 s[78:79]
L_pcf:
    s_lshl_b32 s92, s51, 7
    s_add_u32 s92, s92, (L_opoll - L_pcf)
    v_mov_b32 v4, s92
    s_mov_b64 exec, 1
    global_load_dword v170, v4, s[78:79] sc1
    s_mov_b64 exec, -1
L_slice:
    s_lshl_b32 s92, s48, 5
    s_add_u32 s92, s92, s36
    s_lshl_b32 s42, s92, 13
    s_add_u32 s43, s42, 4096
    s_lshr_b32 s45, s36, 3
    s_lshl_b32 s45, s45, 6
    s_and_b32 s92, s36, 7
    s_lshl_b32 s92, s92, 1
    s_add_u32 s45, s45, s92
    s_mov_b64 s[88:89], -1
    s_mov_b64 s[90:91], -1
    s_lshr_b32 s95, s63, 3
L_s4a:
    ds_read_b32 v5, v15 offset:3084
    s_waitcnt lgkmcnt(0)
    v_cmp_gt_u32 vcc, s95, v5
    s_cbranch_vccnz L_s4a
L_mlpoll:
    buffer_load_dwordx4 v[148:151], v17, s[32:35], s44 offen sc1
    buffer_load_dwordx4 v[152:155], v17, s[32:35], s44 offen offset:1024 sc1
    s_or_b32 s88, s88, 1
    s_wqm_b64 exec, s[88:89]
    buffer_load_dwordx4 v[156:159], v144, s[32:35], s42 offen sc1
    s_or_b32 s90, s90, 1
    s_wqm_b64 exec, s[90:91]
    buffer_load_dwordx4 v[160:163], v144, s[32:35], s43 offen sc1
    s_mov_b64 exec, -1
    s_add_u32 s38, s38, 1
    s_cmp_ge_u32 s38, 0x400000
    s_cbranch_scc1 L_fin
    s_waitcnt vmcnt(2)
    v_cmp_ne_u32 vcc, s57, v150
    v_cmp_ne_u32 s[72:73], s58, v151
    v_cmp_ne_u32 s[74:75], s57, v154
    v_cmp_ne_u32 s[76:77], s58, v155
    v_max_f32 v4, v148, v152
    s_or_b64 vcc, vcc, s[72:73]
    s_or_b64 vcc, vcc, s[74:75]
    s_or_b64 vcc, vcc, s[76:77]
    s_cbranch_scc0 L_w
    s_waitcnt vmcnt(0)
    v_perm_b32 v6, v159, v156, s40
    v_perm_b32 v7, v163, v160, s40
    v_cmp_ne_u32 s[88:89], v6, v147
    v_cmp_ne_u32 s[90:91], v7, v147
    s_branch L_mlpoll
L_w:
    v_max_f32_dpp v4, v4, v4 row_ror:4 row_mask:0xf bank_mask:0xf
    s_nop 1
    v_max_f32_dpp v4, v4, v4 row_ror:8 row_mask:0xf bank_mask:0xf
    v_mov_b32 v5, v4
    s_nop 1
    v_permlane32_swap_b32 v4, v5
    s_nop 0
    v_max_f32 v4, v4, v5
    v_mov_b32 v5, v4
    s_nop 1
    v_permlane16_swap_b32 v4, v5
    s_nop 0
    v_max_f32 v4, v4, v5
    v_sub_f32 v148, v148, v4
    v_sub_f32 v152, v152, v4
    v_exp_f32 v148, v148
    v_exp_f32 v152, v152
    v_mul_f32 v4, v148, v149
    v_fmac_f32 v4, v152, v153
    s_nop 1
    v_add_f32_dpp v4, v4, v4 row_ror:4 row_mask:0xf bank_mask:0xf
    s_nop 1
    v_add_f32_dpp v4, v4, v4 row_ror:8 row_mask:0xf bank_mask:0xf
    v_mov_b32 v5, v4
    s_nop 1
    v_permlane32_swap_b32 v4, v5
    s_nop 0
    v_add_f32 v4, v4, v5
    v_mov_b32 v5, v4
    s_nop 1
    v_permlane16_swap_b32 v4, v5
    s_nop 0
    v_add_f32 v4, v4, v5
    v_rcp_f32 v4, v4
    s_nop 0
    v_mul_f32 v148, v148, v4
    v_mul_f32 v152, v152, v4
    s_branch L_owait
L_opoll:
    s_wqm_b64 exec, s[88:89]
    buffer_load_dwordx4 v[156:159], v144, s[32:35], s42 offen sc1
    s_wqm_b64 exec, s[90:91]
    buffer_load_dwordx4 v[160:163], v144, s[32:35], s43 offen sc1
    s_mov_b64 exec, -1
    s_add_u32 s38, s38, 1
    s_cmp_ge_u32 s38, 0x400000
    s_cbranch_scc1 L_fin
L_owait:
    s_waitcnt vmcnt(0)
    v_perm_b32 v6, v159, v156, s40
    v_perm_b32 v7, v163, v160, s40
    v_cmp_ne_u32 s[88:89], v6, v147
    v_cmp_ne_u32 s[90:91], v7, v147
    v_and_b32 v164, s39, v156
    v_and_b32 v167, s39, v159
    s_or_b64 vcc, s[88:89], s[90:91]
    s_cbranch_scc1 L_opoll
L_fz:
    v_and_b32 v160, s39, v160
    v_and_b32 v163, s39, v163
    v_mul_f32 v164, v164, v148
    v_mul_f32 v165, v157, v148
    v_mul_f32 v166, v158, v148
    v_mul_f32 v167, v167, v148
    v_pk_fma_f32 v[164:165], v[160:161], v[152:153], v[164:165] op_sel_hi:[1,0,1]
    v_pk_fma_f32 v[166:167], v[162:163], v[152:153], v[166:167] op_sel_hi:[1,0,1]
    s_add_u32 s36, s36, 1
    v_permlane32_swap_b32 v164, v165
    v_permlane32_swap_b32 v166, v167
    v_add_f32 v164, v164, v165
    v_add_f32 v166, v166, v167
    s_nop 1
    v_permlane16_swap_b32 v164, v166
    s_cmp_lt_u32 s37, 32
    v_add_f32 v164, v164, v166
    s_nop 1
    v_add_f32_dpp v164, v164, v164 row_ror:4 row_mask:0xf bank_mask:0xf
    s_nop 1
    v_add_f32_dpp v164, v164, v164 row_ror:8 row_mask:0xf bank_mask:0xf
    v_cvt_pk_bf16_f32 v164, v164, v164
    buffer_store_short v164, v146, s[28:31], s45 offen
    s_cbranch_scc0 L_next
    s_endpgm
L_next:
    s_cmp_lt_u32 s36, s37
    s_cbranch_scc1 L_slice
    s_lshl_b32 s92, s48, 7
    s_add_u32 s92, s92, 2195456
    v_mov_b32 v4, s92
    v_mov_b32 v5, s57
    s_mov_b64 exec, 1
    buffer_store_dword v5, v4, s[32:35], 0 offen
L_fin:
L_end:
    s_endpgm
L_mlslow:
    buffer_store_dwordx4 v[76:79], v8, s[32:35], 0 offen sc1
    s_branch L_mldone
L_slowo:
    s_waitcnt vmcnt(0) lgkmcnt(0)
    v_perm_b32 v211, v204, v200, s61
    v_perm_b32 v215, v204, v200, s62
    v_perm_b32 v219, v205, v201, s61
    v_perm_b32 v223, v205, v201, s62
    v_mfma_f32_16x16x32_bf16 v[48:51], v[208:211], v[24:27], v[48:51]
    v_mfma_f32_16x16x32_bf16 v[52:55], v[212:215], v[24:27], v[52:55]
    v_perm_b32 v227, v206, v202, s61
    v_perm_b32 v231, v206, v202, s62
    v_mfma_f32_16x16x32_bf16 v[56:59], v[216:219], v[24:27], v[56:59]
    v_mfma_f32_16x16x32_bf16 v[60:63], v[220:223], v[24:27], v[60:63]
    v_perm_b32 v235, v207, v203, s61
    v_perm_b32 v239, v207, v203, s62
    v_mfma_f32_16x16x32_bf16 v[64:67], v[224:227], v[24:27], v[64:67]
    v_mfma_f32_16x16x32_bf16 v[68:71], v[228:231], v[24:27], v[68:71]
    v_perm_b32 v48, v48, v18, s39
    v_perm_b32 v51, v51, v18, s40
    buffer_store_dwordx4 v[48:51], v42, s[32:35], 0 offen sc1
    v_mfma_f32_16x16x32_bf16 v[72:75], v[232:235], v[24:27], v[72:75]
    v_mfma_f32_16x16x32_bf16 v[76:79], v[236:239], v[24:27], v[76:79]
    v_perm_b32 v52, v52, v18, s39
    v_perm_b32 v55, v55, v18, s40
    buffer_store_dwordx4 v[52:55], v42, s[32:35], s65 offen sc1
    v_perm_b32 v56, v56, v18, s39
    v_perm_b32 v59, v59, v18, s40
    buffer_store_dwordx4 v[56:59], v42, s[32:35], s66 offen sc1
    v_perm_b32 v60, v60, v18, s39
    v_perm_b32 v63, v63, v18, s40
    buffer_store_dwordx4 v[60:63], v42, s[32:35], s67 offen sc1
    v_perm_b32 v64, v64, v18, s39
    v_perm_b32 v67, v67, v18, s40
    buffer_store_dwordx4 v[64:67], v42, s[32:35], s68 offen sc1
    v_perm_b32 v68, v68, v18, s39
    v_perm_b32 v71, v71, v18, s40
    buffer_store_dwordx4 v[68:71], v42, s[32:35], s69 offen sc1
    v_perm_b32 v72, v72, v18, s39
    v_perm_b32 v75, v75, v18, s40
    buffer_store_dwordx4 v[72:75], v42, s[32:35], s70 offen sc1
    v_perm_b32 v76, v76, v18, s39
    v_perm_b32 v79, v79, v18, s40
    buffer_store_dwordx4 v[76:79], v42, s[32:35], s71 offen sc1
    s_branch L_fin
L_notfast:
    s_cbranch_vccnz L_missing
    s_or_b32 s41, s41, 1
    s_cmp_eq_u64 s[76:77], 0
    s_cbranch_scc1 L_modeset
    s_mov_b32 s41, 0x200001
    s_branch L_modeset
L_missing:
    s_add_u32 s38, s38, 1
    s_cmp_ge_u32 s38, 64
    s_cbranch_scc1 L_leave
    buffer_load_dwordx3 v[156:158], v144, s[32:35], s60 offen sc1
    s_branch L_look
L_leave:
    s_lshl_b32 s92, s49, 4
    v_mov_b32 v5, s92
    v_mov_b32 v8, s57
    v_mov_b32 v9, s58
    v_mov_b32 v10, 0x100
    s_mov_b64 exec, 1
    buffer_store_dwordx3 v[8:10], v5, s[32:35], s60 offen sc1
    s_mov_b64 exec, -1
    s_waitcnt vmcnt(0)
    buffer_load_dwordx3 v[156:158], v144, s[32:35], s60 offen sc1
    s_waitcnt vmcnt(0)
    v_cmp_ne_u32 vcc, s57, v156
    v_cmp_ne_u32 s[72:73], s58, v157
    s_nop 0
    s_or_b64 vcc, vcc, s[72:73]
    s_cselect_b32 s41, 1, 0x200001
    s_branch L_modeset
L_vbad0:
    v_mov_b32 v80, 0
    v_mov_b32 v81, 0
    v_mov_b32 v82, 0
    v_mov_b32 v83, 0
    v_mov_b32 v84, 0
    v_mov_b32 v85, 0
    v_mov_b32 v86, 0
    v_mov_b32 v87, 0
    s_branch L_vgood0
L_vbad1:
    v_mov_b32 v88, 0
    v_mov_b32 v89, 0
    v_mov_b32 v90, 0
    v_mov_b32 v91, 0
    v_mov_b32 v92, 0
    v_mov_b32 v93, 0
    v_mov_b32 v94, 0
    v_mov_b32 v95, 0
    s_branch L_vgood1
L_vbad2:
    v_mov_b32 v96, 0
    v_mov_b32 v97, 0
    v_mov_b32 v98, 0
    v_mov_b32 v99, 0
    v_mov_b32 v100, 0
    v_mov_b32 v101, 0
    v_mov_b32 v102, 0
    v_mov_b32 v103, 0
    s_branch L_vgood2
L_vbad3:
    v_mov_b32 v104, 0
    v_mov_b32 v105, 0
    v_mov_b32 v106, 0
    v_mov_b32 v107, 0
    v_mov_b32 v108, 0
    v_mov_b32 v109, 0
    v_mov_b32 v110, 0
    v_mov_b32 v111, 0
    s_branch L_vgood3
L_vbad4:
    v_mov_b32 v112, 0
    v_mov_b32 v113, 0
    v_mov_b32 v114, 0
    v_mov_b32 v115, 0
    v_mov_b32 v116, 0
    v_mov_b32 v117, 0
    v_mov_b32 v118, 0
    v_mov_b32 v119, 0
    s_branch L_vgood4
L_vbad5:
    v_mov_b32 v120, 0
    v_mov_b32 v121, 0
    v_mov_b32 v122, 0
    v_mov_b32 v123, 0
    v_mov_b32 v124, 0
    v_mov_b32 v125, 0
    v_mov_b32 v126, 0
    v_mov_b32 v127, 0
    s_branch L_vgood5
L_vbad6:
    v_mov_b32 v128, 0
    v_mov_b32 v129, 0
    v_mov_b32 v130, 0
    v_mov_b32 v131, 0
    v_mov_b32 v132, 0
    v_mov_b32 v133, 0
    v_mov_b32 v134, 0
    v_mov_b32 v135, 0
    s_branch L_vgood6
L_vbad7:
    v_mov_b32 v136, 0
    v_mov_b32 v137, 0
    v_mov_b32 v138, 0
    v_mov_b32 v139, 0
    v_mov_b32 v140, 0
    v_mov_b32 v141, 0
    v_mov_b32 v142, 0
    v_mov_b32 v143, 0
    s_branch L_vgood7
L_vbad8:
    v_mov_b32 v144, 0
    v_mov_b32 v145, 0
    v_mov_b32 v146, 0
    v_mov_b32 v147, 0
    v_mov_b32 v148, 0
    v_mov_b32 v149, 0
    v_mov_b32 v150, 0
    v_mov_b32 v151, 0
    s_branch L_vgood8
L_vbad9:
    v_mov_b32 v152, 0
    v_mov_b32 v153, 0
    v_mov_b32 v154, 0
    v_mov_b32 v155, 0
    v_mov_b32 v156, 0
    v_mov_b32 v157, 0
    v_mov_b32 v158, 0
    v_mov_b32 v159, 0
    s_branch L_vgood9
L_vbad10:
    v_mov_b32 v160, 0
    v_mov_b32 v161, 0
    v_mov_b32 v162, 0
    v_mov_b32 v163, 0
    v_mov_b32 v164, 0
    v_mov_b32 v165, 0
    v_mov_b32 v166, 0
    v_mov_b32 v167, 0
    s_branch L_vgood10
L_vbad11:
    v_mov_b32 v168, 0
    v_mov_b32 v169, 0
    v_mov_b32 v170, 0
    v_mov_b32 v171, 0
    v_mov_b32 v172, 0
    v_mov_b32 v173, 0
    v_mov_b32 v174, 0
    v_mov_b32 v175, 0
    s_branch L_vgood11
L_pagain0:
    ds_read_b32 v6, v15 offset:3076
    ds_read_b128 v[20:23], v17 offset:8192
    ds_read_b32 v4, v44 offset:256
    s_waitcnt lgkmcnt(0)
    v_cmp_gt_u32 vcc, s63, v6
    s_cbranch_vccnz L_pagain0
    s_branch L_pok0
L_pagain1:
    ds_read_b32 v6, v15 offset:3076
    ds_read_b128 v[20:23], v17 offset:16384
    ds_read_b32 v4, v44 offset:512
    ds_read_b32 v19, v15 offset:3104
    s_waitcnt lgkmcnt(0)
    v_cmp_gt_u32 vcc, s63, v6
    s_cbranch_vccnz L_pagain1
    s_branch L_pok1
L_kmore:
    s_waitcnt lgkmcnt(0)
    s_barrier
    s_mov_b32 s55, 0
    s_mov_b32 s56, 0
    s_ff1_i32_b32 s92, s53
    s_bitset0_b32 s53, s92
    s_lshl_b32 s96, s92, 4
    s_addk_i32 s96, 128
    s_cmp_lt_i32 s92, 0
    s_cselect_b32 s96, 2112, s96
    v_add_u32 v52, s96, v47
    ds_read_b32 v52, v52 offset:1024
    s_ff1_i32_b32 s92, s53
    s_bitset0_b32 s53, s92
    s_lshl_b32 s96, s92, 4
    s_addk_i32 s96, 128
    s_cmp_lt_i32 s92, 0
    s_cselect_b32 s96, 2112, s96
    v_add_u32 v53, s96, v47
    ds_read_b32 v53, v53 offset:1024
    s_branch L_kround
L_vmore:
    s_waitcnt vmcnt(0) lgkmcnt(0)
    v_perm_b32 v211, v204, v200, s61
    v_perm_b32 v215, v204, v200, s62
    v_perm_b32 v219, v205, v201, s61
    v_perm_b32 v223, v205, v201, s62
    v_perm_b32 v227, v206, v202, s61
    v_perm_b32 v231, v206, v202, s62
    v_perm_b32 v235, v207, v203, s61
    v_perm_b32 v239, v207, v203, s62
    v_mfma_f32_16x16x32_bf16 v[48:51], v[208:211], v[24:27], v[48:51]
    v_mfma_f32_16x16x32_bf16 v[52:55], v[212:215], v[24:27], v[52:55]
    v_mfma_f32_16x16x32_bf16 v[56:59], v[216:219], v[24:27], v[56:59]
    v_mfma_f32_16x16x32_bf16 v[60:63], v[220:223], v[24:27], v[60:63]
    v_mfma_f32_16x16x32_bf16 v[64:67], v[224:227], v[24:27], v[64:67]
    v_mfma_f32_16x16x32_bf16 v[68:71], v[228:231], v[24:27], v[68:71]
    v_mfma_f32_16x16x32_bf16 v[72:75], v[232:235], v[24:27], v[72:75]
    v_mfma_f32_16x16x32_bf16 v[76:79], v[236:239], v[24:27], v[76:79]
    s_barrier
    s_mov_b32 s55, 0
    s_mov_b32 s54, 1
    s_mov_b32 s84, s85
    s_mov_b32 s56, s85
    v_mov_b32 v8, v45
    s_nop 1
    v_permlane32_swap_b32 v8, v45
    s_nop 1
    v_readlane_b32 s80, v45, 0
    s_bitcmp1_b32 s84, 0
    s_cselect_b32 s22, s86, 0
    s_mov_b32 m0, 8192
    s_nop 1
    buffer_load_dwordx4 v36, s[20:23], s80 offen offset:0  lds
    buffer_load_dwordx4 v37, s[20:23], s80 offen offset:1024  lds
    buffer_load_dwordx4 v38, s[20:23], s80 offen offset:2048  lds
    buffer_load_dwordx4 v39, s[20:23], s80 offen offset:3072  lds
    v_readlane_b32 s80, v45, 1
    s_bitcmp1_b32 s84, 1
    s_cselect_b32 s22, s86, 0
    s_mov_b32 m0, 12288
    s_nop 1
    buffer_load_dwordx4 v36, s[20:23], s80 offen offset:0  lds
    buffer_load_dwordx4 v37, s[20:23], s80 offen offset:1024  lds
    buffer_load_dwordx4 v38, s[20:23], s80 offen offset:2048  lds
    buffer_load_dwordx4 v39, s[20:23], s80 offen offset:3072  lds
    v_readlane_b32 s80, v45, 2
    s_bitcmp1_b32 s84, 2
    s_cselect_b32 s22, s86, 0
    s_mov_b32 m0, 16384
    s_nop 1
    buffer_load_dwordx4 v36, s[20:23], s80 offen offset:0  lds
    buffer_load_dwordx4 v37, s[20:23], s80 offen offset:1024  lds
    buffer_load_dwordx4 v38, s[20:23], s80 offen offset:2048  lds
    buffer_load_dwordx4 v39, s[20:23], s80 offen offset:3072  lds
    v_readlane_b32 s80, v45, 3
    s_bitcmp1_b32 s84, 3
    s_cselect_b32 s22, s86, 0
    s_mov_b32 m0, 20480
    s_nop 1
    buffer_load_dwordx4 v36, s[20:23], s80 offen offset:0  lds
    buffer_load_dwordx4 v37, s[20:23], s80 offen offset:1024  lds
    buffer_load_dwordx4 v38, s[20:23], s80 offen offset:2048  lds
    buffer_load_dwordx4 v39, s[20:23], s80 offen offset:3072  lds
    v_readlane_b32 s80, v45, 4
    s_bitcmp1_b32 s84, 4
    s_cselect_b32 s22, s86, 0
    s_mov_b32 m0, 24576
    s_nop 1
    buffer_load_dwordx4 v36, s[20:23], s80 offen offset:0  lds
    buffer_load_dwordx4 v37, s[20:23], s80 offen offset:1024  lds
    buffer_load_dwordx4 v38, s[20:23], s80 offen offset:2048  lds
    buffer_load_dwordx4 v39, s[20:23], s80 offen offset:3072  lds
    v_readlane_b32 s80, v45, 5
    s_bitcmp1_b32 s84, 5
    s_cselect_b32 s22, s86, 0
    s_mov_b32 m0, 28672
    s_nop 1
    buffer_load_dwordx4 v36, s[20:23], s80 offen offset:0  lds
    buffer_load_dwordx4 v37, s[20:23], s80 offen offset:1024  lds
    buffer_load_dwordx4 v38, s[20:23], s80 offen offset:2048  lds
    buffer_load_dwordx4 v39, s[20:23], s80 offen offset:3072  lds
    v_readlane_b32 s82, v45, 6
    s_branch L_vround
.if (. - L_pc) < (17408 + 104)
.fill ((17408 + 104 - (. - L_pc)) / 4), 4, 0xbf810000
.endif
L_codeend:
.section .rodata,"a"
.p2align 6
.amdhsa_kernel standalone__paged_block_table_kv_radixattention__decode_kernel
  .amdhsa_next_free_vgpr 240
  .amdhsa_next_free_sgpr 102
  .amdhsa_accum_offset 240
  .amdhsa_group_segment_fixed_size 0
  .amdhsa_kernarg_size 64
  .amdhsa_user_sgpr_count 2
  .amdhsa_user_sgpr_kernarg_segment_ptr 1
  .amdhsa_system_sgpr_workgroup_id_x 1
.end_amdhsa_kernel
```
